```python
import torch

def _softmax(x, axis=-1):
    return torch.softmax(x, dim=axis)
def _gelu(x):
    return torch.nn.functional.gelu(x, approximate="tanh")
def _silu(x):
    return torch.nn.functional.silu(x)
def _sigmoid(x):
    return torch.sigmoid(x)
def _layernorm(x, axis=-1, eps=1e-5):
    m = x.mean(dim=axis, keepdim=True)
    v = x.var(dim=axis, keepdim=True, unbiased=False)
    return (x - m) / torch.sqrt(v + eps)
def _scatter_add(tgt, idx, src, axis=0):
    return tgt.clone().index_add_(axis, idx, src)
def _segment_sum(src, seg, n):
    out = torch.zeros((n,) + src.shape[1:], dtype=src.dtype)
    return out.index_add_(0, seg, src)
def _pad(x, pw):
    flat = tuple(v for pair in reversed(pw) for v in pair)
    return torch.nn.functional.pad(x, flat)

kernel_name = 'recurrent_scan__gqa_block_cached__glu_gated_reglu__decode'

def setup_inputs():

    _w = (lambda a: (lambda t: t.to(torch.bfloat16) if t.is_floating_point() else t)(torch.as_tensor(a)))
    def _A_setup():
        B, Sq, D = 2, 1, 512
        Hq, Hkv, Sk, Dh = 32, 8, 32768, 128
        assert Hq % Hkv == 0, (Hq, Hkv)
        return {
            "x": _w((lambda *s: torch.randn(*s, dtype=torch.bfloat16) * 0.4)(B, Sq, D)),
            "k_cache": _w((lambda *s: torch.randn(*s, dtype=torch.bfloat16) * 1.6)(B, Hkv, Sk, Dh)),
            "v_cache": _w((lambda *s: torch.randn(*s, dtype=torch.bfloat16) * 1.6)(B, Hkv, Sk, Dh)),
            "wq": _w((lambda *s: torch.randn(*s, dtype=torch.bfloat16) * 1.6)(D, Hq * Dh) * (D ** -0.5)),
            "wo": _w((lambda *s: torch.randn(*s, dtype=torch.bfloat16) * 1.6)(Hq * Dh, D) * ((Hq * Dh) ** -0.5)),
        }
    _A_in = _A_setup()

    def _B_setup():
        B, S, D, F = 2, 1, 512, 1792
        return {
            "x": _w((lambda *s: torch.randn(*s, dtype=torch.bfloat16) * 0.4)(B, S, D)),
            "W_gate": _w((lambda *s: torch.randn(*s, dtype=torch.bfloat16) * 1.6)(D, F) * (2.0 / D) ** 0.5),
            "W_up": _w((lambda *s: torch.randn(*s, dtype=torch.bfloat16) * 1.6)(D, F) * (2.0 / D) ** 0.5),
            "W_down": _w((lambda *s: torch.randn(*s, dtype=torch.bfloat16) * 1.6)(F, D) * (1.0 / F) ** 0.5),
        }
    _B_in = _B_setup()

    return {
        "A_x": _A_in["x"],
        "A_k_cache": _A_in["k_cache"],
        "A_v_cache": _A_in["v_cache"],
        "A_wq": _A_in["wq"],
        "A_wo": _A_in["wo"],
        "B_x": _B_in["x"],
        "B_W_gate": _B_in["W_gate"],
        "B_W_up": _B_in["W_up"],
        "B_W_down": _B_in["W_down"],
    }

def reference(A_x, A_k_cache, A_v_cache, A_wq, A_wo, B_x, B_W_gate, B_W_up, B_W_down):
    def _A_ref(x, k_cache, v_cache, wq, wo):
        B, Sq, D = x.shape
        Hq, Dh = 32, 128
        Hkv = k_cache.shape[1]
        rep = Hq // Hkv
        q = (lambda x, *d: x.permute(*d))((x @ wq).reshape(B, Sq, Hq, Dh), 0, 2, 1, 3)
        k = (lambda x, n, axis: torch.repeat_interleave(x, n, dim=axis))(k_cache, rep, axis=1)
        v = (lambda x, n, axis: torch.repeat_interleave(x, n, dim=axis))(v_cache, rep, axis=1)
        scores = torch.einsum("bhqd,bhkd->bhqk", q, k) * (Dh ** -0.5)
        p = _softmax(scores, axis=-1)
        o = torch.einsum("bhqk,bhkd->bhqd", p, v)
        return (lambda x, *d: x.permute(*d))(o, 0, 2, 1, 3).reshape(B, Sq, Hq * Dh) @ wo

    def _B_ref(x, W_gate, W_up, W_down):
        gate = torch.einsum("bsd,df->bsf", x, W_gate)
        up = torch.einsum("bsd,df->bsf", x, W_up)
        gate = gate * (lambda x, dt: x.to(dt))(gate > 0, gate.dtype)
        h = gate * up
        return torch.einsum("bsf,fd->bsd", h, W_down)

    x = A_x
    xn = _layernorm(x, axis=-1)
    s = _A_ref(xn, A_k_cache, A_v_cache, A_wq, A_wo)
    g = _silu(_B_ref(xn, B_W_gate, B_W_up, B_W_down))
    return x + s * g
```

```asm
; @launch grid=(256,1,1) block=(384,1,1) lds=47616
.amdgcn_target "amdgcn-amd-amdhsa--gfx950"
.text
.globl recurrent_scan__gqa_block_cached__glu_gated_reglu__decode_kernel
.p2align 8
.type recurrent_scan__gqa_block_cached__glu_gated_reglu__decode_kernel,@function
recurrent_scan__gqa_block_cached__glu_gated_reglu__decode_kernel:
    s_load_dwordx16 s[4:19], s[0:1], 0
    s_load_dwordx8 s[20:27], s[0:1], 64
    v_lshrrev_b32 v1, 6, v0
    s_cmpk_ge_u32 s2, 256
    s_cbranch_scc1 L_end
    v_readfirstlane_b32 s3, v1
    v_and_b32 v0, 63, v0
    s_mul_i32 s39, s2, 0x200408
    s_and_b32 s39, s39, 0x201f80
    s_sub_u32 s42, s3, 1
    s_cbranch_scc1 L_xwave
    s_cmp_eq_u32 s3, 5
    s_cbranch_scc1 L_wwave
    s_lshl_b32 s36, s42, 19
    s_or_b32 s36, s36, s39
    s_movk_i32 s37, 8192
    s_mov_b32 s35, 24
    s_bitcmp0_b32 s2, 3
    s_cbranch_scc1 L_job
    s_andn2_b32 s35, 0x86, s2
    s_cbranch_scc0 L_srest
    s_lshr_b32 s36, s2, 3
    s_and_b32 s37, s36, 24
    s_min_u32 s37, s37, 22
    s_and_b32 s35, s2, 7
    s_add_u32 s37, s37, s35
    s_and_b32 s36, s36, 6
    s_and_b32 s35, s42, 1
    s_or_b32 s36, s36, s35
    s_mulk_i32 s36, 1792
    s_add_u32 s36, s36, s37
    s_lshl_b32 s36, s36, 7
    s_movk_i32 s37, 3584
    s_lshr_b32 s35, s42, 1
    s_lshl3_add_u32 s35, s35, 48
L_job:
    s_load_dwordx2 s[40:41], s[0:1], s35
    v_lshrrev_b32 v2, 3, v0
    v_and_b32 v3, 7, v0
    v_mul_u32_u24 v2, s37, v2
    v_lshl_add_u32 v2, v3, 4, v2
    v_add_u32 v2, s36, v2
    s_lshl_b32 m0, s42, 13
    s_lshl_b32 s37, s37, 3
    s_lshl_b32 s36, s3, 13
    s_waitcnt lgkmcnt(0)
L_wdma:
    global_load_lds_dwordx4 v2, s[40:41] nt
    s_addk_i32 m0, 1024
    v_add_u32 v2, s37, v2
    s_cmp_lg_u32 m0, s36
    s_cbranch_scc1 L_wdma
    s_branch L_srest
.p2align 8
L_xwave:
    v_lshlrev_b32 v1, 5, v0
    v_mov_b32 v6, 0
    v_mov_b32 v7, 0
    v_lshlrev_b32 v5, 3, v0
    ds_write_b64 v5, v[6:7] offset:37888
    s_waitcnt lgkmcnt(0)
    global_load_dwordx4 v[8:11], v1, s[4:5]
    global_load_dwordx4 v[12:15], v1, s[4:5] offset:16
    s_load_dword s33, s[26:27], 0
    s_setprio 2
    s_and_b32 s28, s2, 7
    s_lshr_b32 s29, s2, 3
    s_bfe_u32 s30, s2, 0x30004
    s_lshr_b32 s31, s2, 7
    s_and_b32 s32, s2, 15
    s_and_b32 s34, s29, 15
    s_and_b32 s35, s2, 3
    s_lshl2_add_u32 s34, s34, s35
    s_lshr_b32 s38, s2, 4
    s_and_b32 s67, s39, 0x200300
    s_and_b32 s36, s2, 8
    s_or_b32 s67, s67, s36
    s_cbranch_scc1 L_x2
    s_bfe_u32 s36, s39, 0x3000a
    s_bfe_u32 s37, s39, 0x10007
    s_lshl3_add_u32 s36, s37, s36
    s_mul_i32 s36, s36, 1280
    s_add_u32 s36, s36, 393216
    v_lshl_add_u32 v5, v0, 2, s36
    global_store_dword v5, v6, s[26:27] sc1
    s_branch L_x2
.p2align 6
L_srest:
    s_waitcnt lgkmcnt(0)
    s_and_b32 s28, s2, 7
    s_lshr_b32 s29, s2, 3
    s_bfe_u32 s30, s2, 0x30004
    s_lshr_b32 s31, s2, 7
    s_and_b32 s32, s2, 15
    s_and_b32 s34, s29, 15
    s_and_b32 s35, s2, 3
    s_lshl2_add_u32 s34, s34, s35
    s_lshr_b32 s38, s2, 4
    s_mov_b64 s[44:45], s[6:7]
    s_brev_b32 s46, 16
    s_mov_b32 s47, 0x20000
    s_mov_b64 s[48:49], s[8:9]
    s_brev_b32 s50, 16
    s_mov_b32 s51, 0x20000
    s_mov_b64 s[72:73], s[6:7]
    s_brev_b32 s74, 16
    s_mov_b32 s75, 0x20000
    s_lshl_b32 s66, s38, 23
    s_lshl_b32 s35, s42, 11
    s_xor_b32 s66, s66, s35
    s_bfe_i32 s35, s32, 0x10000
    s_and_b32 s35, s35, 0x84000
    s_xor_b32 s66, s66, s35
    s_bfe_i32 s35, s32, 0x10001
    s_and_b32 s35, s35, 0x120000
    s_xor_b32 s66, s66, s35
    s_bfe_i32 s35, s32, 0x10002
    s_and_b32 s35, s35, 0x200000
    s_xor_b32 s66, s66, s35
    s_bfe_i32 s35, s32, 0x10003
    s_and_b32 s35, s35, 0x402000
    s_xor_b32 s66, s66, s35
    s_bfe_i32 s35, s38, 0x10000
    s_and_b32 s35, s35, 0x2000
    s_xor_b32 s66, s66, s35
    v_lshrrev_b32 v2, 4, v0
    v_and_b32 v3, 3, v0
    v_bfe_u32 v4, v0, 2, 2
    v_lshlrev_b32 v5, 8, v4
    v_lshl_add_u32 v5, v2, 6, v5
    v_lshl_add_u32 v18, v3, 4, v5
    s_mov_b32 s52, s66
    s_waitcnt vmcnt(8)
    buffer_load_dwordx4 v[124:127], v18, s[44:47], s52 offen offset:0 nt
    s_bitset1_b32 s52, 15
    buffer_load_dwordx4 v[132:135], v18, s[44:47], s52 offen offset:0 nt
    s_bitset0_b32 s52, 15
    buffer_load_dwordx4 v[128:131], v18, s[44:47], s52 offen offset:1024 nt
    s_bitset1_b32 s52, 15
    buffer_load_dwordx4 v[136:139], v18, s[44:47], s52 offen offset:1024 nt
    v_lshlrev_b32 v19, 4, v0
    v_mov_b32 v10, s66
    v_bfe_i32 v7, v0, 0, 1
    v_and_b32 v7, 0x2000, v7
    v_xor_b32 v10, v10, v7
    v_bfe_i32 v7, v0, 1, 1
    v_and_b32 v7, 0x10000, v7
    v_xor_b32 v10, v10, v7
    v_bfe_i32 v7, v0, 2, 1
    v_and_b32 v7, 0x4000, v7
    v_xor_b32 v10, v10, v7
    v_bfe_i32 v7, v0, 3, 1
    v_and_b32 v7, 0x20000, v7
    v_xor_b32 v10, v10, v7
    v_bfe_i32 v7, v0, 4, 1
    v_and_b32 v7, 0x40000, v7
    v_xor_b32 v10, v10, v7
    s_mov_b32 s55, 0
    s_lshl_b32 s35, s42, 11
    s_xor_b32 s55, s55, s35
    s_lshl_b32 s36, s42, 2
    v_mov_b32 v14, s36
    v_mov_b32 v6, 0xffff
    v_mov_b32 v7, 0xffff0000
    v_and_b32 v8, 1, v0
    v_cmp_eq_u32 vcc, 1, v8
    v_lshlrev_b32 v208, 4, v8
    v_and_b32 v8, 2, v0
    v_cndmask_b32 v6, v6, v7, vcc
    v_cmp_eq_u32 vcc, 2, v8
    v_mov_b32 v20, 0xff61b1e6
    v_mov_b32 v21, 0
    v_cndmask_b32 v23, 0, v6, vcc
    v_xor_b32 v22, v23, v6
    v_mov_b32 v36, 0
    v_mov_b32 v37, 0
    v_mov_b32 v38, 0
    v_mov_b32 v39, 0
    v_mov_b32 v40, 0
    v_mov_b32 v41, 0
    v_mov_b32 v42, 0
    v_mov_b32 v43, 0
    s_mov_b32 s53, 0x3fb8aa3b
    s_mov_b32 s43, 0x3db504f3
    s_mov_b32 s67, 0xffff0000
    s_mov_b32 s54, 1
    s_mov_b32 s41, 8
    s_mov_b32 s76, 4
    s_mov_b32 s77, 6
    s_mov_b64 s[96:97], -1
    s_mov_b32 s98, 0x11111111
    s_mov_b32 s99, 0x11111111
    v_mov_b32 v11, v18
    s_mul_i32 s36, s42, 7168
    v_lshl_add_u32 v16, v0, 2, s36
    v_and_b32 v12, -16, v16
    v_lshlrev_b32 v210, 3, v3
    v_lshlrev_b32 v211, 3, v2
    v_and_b32 v8, 16, v0
    v_mov_b32 v6, 0x0c0c0400
    v_alignbit_b32 v209, v6, v6, v8
    s_lshl_b32 s35, s42, 11
    v_lshl_add_u32 v188, v0, 5, s35
    s_lshl_b32 s36, s42, 3
    v_lshl_add_u32 v189, v4, 5, s36
    v_and_b32 v1, 31, v0
    s_lshl_b32 s35, s42, 9
    v_lshl_add_u32 v190, v1, 4, s35
    s_lshl_b32 s36, s42, 5
    v_mov_b32 v191, s36
    v_lshl_add_u32 v194, v2, 3, s36
    s_lshl_b32 s35, s2, 11
    s_add_u32 s35, s35, 1048576
    v_add_u32 v192, s35, v190
    s_and_b32 s36, s34, 7
    s_lshl_b32 s36, s36, 8
    s_lshl_b32 s37, s42, 6
    s_add_u32 s36, s36, s37
    v_lshl_add_u32 v207, v2, 4, s36
    v_and_b32 v5, 15, v0
    s_lshl_b32 s36, s38, 15
    s_add_u32 s36, s36, 1048576
    v_lshl_add_u32 v193, v5, 11, s36
    v_add_u32 v193, v193, v207
    s_lshl_b32 s100, 0x10001, s32
    s_not_b32 s100, s100
    s_mov_b32 s101, s100
    v_and_b32 v5, 7, v0
    v_lshrrev_b32 v3, 3, v0
    s_lshl_b32 s36, s42, 2
    s_add_u32 s36, s36, s34
    s_lshl_b32 s36, s36, 3
    v_lshl_add_u32 v1, v5, 2, v2
    v_add_u32 v1, s36, v1
    v_and_b32 v1, 127, v1
    s_lshr_b32 s35, s28, 2
    s_lshl1_add_u32 s36, s31, s35
    s_lshl_b32 s36, s36, 6
    s_add_u32 s36, s36, s34
    s_lshl_b32 s36, s36, 11
    s_add_u32 s36, s36, 524288
    v_lshl_add_u32 v195, v1, 4, s36
    s_lshl2_add_u32 s36, s35, s42
    s_lshl_b32 s36, s36, 7
    v_lshl_add_u32 v1, v5, 4, s36
    s_lshl_b32 s36, s34, 16
    s_add_u32 s36, s36, 4096
    v_lshl_add_u32 v6, v3, 13, s36
    v_add_u32 v196, v1, v6
    s_mul_i32 s36, s34, 28672
    v_min_u32 v6, 6, v3
    v_lshl_add_u32 v6, v6, 12, s36
    v_add_u32 v202, v1, v6
    v_lshlrev_b32 v197, 3, v3
    v_lshlrev_b32 v203, 4, v3
    s_lshr_b32 s35, s28, 2
    s_and_b32 s36, s28, 2
    s_or_b32 s35, s35, s36
    s_and_b32 s36, s28, 1
    s_lshr_b32 s37, s29, 2
    s_lshl3_add_u32 s36, s36, s37
    v_lshlrev_b32 v5, 4, v5
    s_lshl_b32 s37, s42, 7
    v_lshl_add_u32 v1, v2, 2, v5
    v_add_u32 v204, s37, v1
    s_lshl2_add_u32 s37, s35, s42
    s_lshl_b32 s37, s37, 15
    s_add_u32 s37, s37, 524288
    v_add_u32 v5, s37, v5
    v_add_u32 v1, 0, v3
    v_add_u32 v6, s36, v1
    v_and_b32 v6, 15, v6
    v_lshl_add_u32 v6, v6, 7, v5
    v_lshl_add_u32 v198, v1, 11, v6
    v_add_u32 v1, 8, v3
    v_add_u32 v6, s36, v1
    v_and_b32 v6, 15, v6
    v_lshl_add_u32 v6, v6, 7, v5
    v_lshl_add_u32 v199, v1, 11, v6
    s_lshl_b32 s37, s35, 9
    s_lshl_b32 s36, s36, 5
    s_add_u32 s37, s37, s36
    v_and_b32 v1, 15, v0
    v_lshl_add_u32 v200, v1, 1, s37
    v_lshrrev_b32 v1, 1, v1
    v_lshlrev_b32 v1, 4, v1
    v_lshrrev_b32 v5, 2, v208
    v_add_u32 v1, v1, v5
    v_add_u32 v205, 39424, v1
    v_lshrrev_b32 v7, 4, v195
    v_xor_b32 v7, v7, v195
    v_bfe_i32 v7, v7, 13, 1
    v_and_b32 v7, 0x22000, v7
    v_xor_b32 v195, v195, v7
    v_lshrrev_b32 v7, 4, v198
    v_xor_b32 v7, v7, v198
    v_bfe_i32 v7, v7, 13, 1
    v_and_b32 v7, 0x22000, v7
    v_xor_b32 v198, v198, v7
    v_lshrrev_b32 v7, 4, v199
    v_xor_b32 v7, v7, v199
    v_bfe_i32 v7, v7, 13, 1
    v_and_b32 v7, 0x22000, v7
    v_xor_b32_e64 v199, v199, v7
    s_mov_b32 s60, 0x07060500
    s_mov_b32 s61, 0x07060501
    s_mov_b32 s64, 0x05040100
    s_mov_b32 s65, 0x07060302
    s_mov_b32 s68, 0x00ff00ff
    s_mov_b32 s69, 0x00ff00ff
    s_mov_b32 s39, 0xffffff00
    v_mov_b32 v6, 0
    s_waitcnt vmcnt(4)
    s_barrier
    s_xor_b32 s52, s66, 0x2000
    s_waitcnt vmcnt(4)
    buffer_load_dwordx4 v[140:143], v18, s[44:47], s52 offen offset:0 nt
    s_bitset1_b32 s52, 15
    s_waitcnt vmcnt(4)
    buffer_load_dwordx4 v[148:151], v18, s[44:47], s52 offen offset:0 nt
    s_bitset0_b32 s52, 15
    s_waitcnt vmcnt(4)
    buffer_load_dwordx4 v[144:147], v18, s[44:47], s52 offen offset:1024 nt
    s_bitset1_b32 s52, 15
    s_waitcnt vmcnt(4)
    buffer_load_dwordx4 v[152:155], v18, s[44:47], s52 offen offset:1024 nt
    s_xor_b32 s52, s66, 0x10000
    s_waitcnt vmcnt(4)
    buffer_load_dwordx4 v[156:159], v18, s[44:47], s52 offen offset:0 nt
    s_bitset1_b32 s52, 15
    s_waitcnt vmcnt(4)
    buffer_load_dwordx4 v[164:167], v18, s[44:47], s52 offen offset:0 nt
    s_bitset0_b32 s52, 15
    s_waitcnt vmcnt(4)
    buffer_load_dwordx4 v[160:163], v18, s[44:47], s52 offen offset:1024 nt
    s_bitset1_b32 s52, 15
    s_waitcnt vmcnt(4)
    buffer_load_dwordx4 v[168:171], v18, s[44:47], s52 offen offset:1024 nt
    s_xor_b32 s52, s66, 0x12000
    s_waitcnt vmcnt(4)
    buffer_load_dwordx4 v[172:175], v18, s[44:47], s52 offen offset:0 nt
    s_bitset1_b32 s52, 15
    s_waitcnt vmcnt(4)
    buffer_load_dwordx4 v[180:183], v18, s[44:47], s52 offen offset:0 nt
    s_bitset0_b32 s52, 15
    s_waitcnt vmcnt(4)
    buffer_load_dwordx4 v[176:179], v18, s[44:47], s52 offen offset:1024 nt
    s_bitset1_b32 s52, 15
    s_waitcnt vmcnt(4)
    buffer_load_dwordx4 v[184:187], v18, s[44:47], s52 offen offset:1024 nt
    s_xor_b32 s52, s66, 0x4000
    s_waitcnt vmcnt(4)
    buffer_load_dwordx4 v[92:95], v18, s[44:47], s52 offen offset:0 nt
    s_bitset1_b32 s52, 15
    s_waitcnt vmcnt(4)
    buffer_load_dwordx4 v[100:103], v18, s[44:47], s52 offen offset:0 nt
    s_bitset0_b32 s52, 15
    s_waitcnt vmcnt(4)
    buffer_load_dwordx4 v[96:99], v18, s[44:47], s52 offen offset:1024 nt
    s_bitset1_b32 s52, 15
    s_waitcnt vmcnt(4)
    buffer_load_dwordx4 v[104:107], v18, s[44:47], s52 offen offset:1024 nt
    s_mov_b64 exec, 1
    v_mov_b32 v15, 1
    ds_write_b32 v14, v15 offset:38160
    s_mov_b64 exec, -1
    s_xor_b32 s52, s66, 0x6000
    s_waitcnt vmcnt(4)
    buffer_load_dwordx4 v[76:79], v18, s[44:47], s52 offen offset:0 nt
    s_bitset1_b32 s52, 15
    s_waitcnt vmcnt(4)
    buffer_load_dwordx4 v[84:87], v18, s[44:47], s52 offen offset:0 nt
    s_bitset0_b32 s52, 15
    s_waitcnt vmcnt(4)
    buffer_load_dwordx4 v[80:83], v18, s[44:47], s52 offen offset:1024 nt
    s_bitset1_b32 s52, 15
    s_waitcnt vmcnt(4)
    buffer_load_dwordx4 v[88:91], v18, s[44:47], s52 offen offset:1024 nt
    s_xor_b32 s52, s66, 0x14000
    s_waitcnt vmcnt(4)
    buffer_load_dwordx4 v[108:111], v18, s[44:47], s52 offen offset:0 nt
    s_bitset1_b32 s52, 15
    s_waitcnt vmcnt(4)
    buffer_load_dwordx4 v[116:119], v18, s[44:47], s52 offen offset:0 nt
    s_bitset0_b32 s52, 15
    s_waitcnt vmcnt(4)
    buffer_load_dwordx4 v[112:115], v18, s[44:47], s52 offen offset:1024 nt
    s_bitset1_b32 s52, 15
    s_waitcnt vmcnt(4)
    buffer_load_dwordx4 v[120:123], v18, s[44:47], s52 offen offset:1024 nt
    s_xor_b32 s52, s66, 0x16000
    s_waitcnt vmcnt(4)
    buffer_load_dwordx4 v[60:63], v18, s[44:47], s52 offen offset:0 nt
    s_bitset1_b32 s52, 15
    s_waitcnt vmcnt(4)
    buffer_load_dwordx4 v[68:71], v18, s[44:47], s52 offen offset:0 nt
    s_bitset0_b32 s52, 15
    s_waitcnt vmcnt(4)
    buffer_load_dwordx4 v[64:67], v18, s[44:47], s52 offen offset:1024 nt
    s_bitset1_b32 s52, 15
    s_waitcnt vmcnt(4)
    buffer_load_dwordx4 v[72:75], v18, s[44:47], s52 offen offset:1024 nt
    s_mov_b32 s40, 8388608
L_qflag:
    ds_read_b64 v[2:3], v6 offset:38144
    s_waitcnt lgkmcnt(0)
    v_cmp_ne_u32 vcc, 0, v3
    s_cbranch_vccnz L_qflag_done
    s_sleep 1
    s_sub_u32 s40, s40, 1
    s_cbranch_scc0 L_qflag
L_qflag_done:
    ds_read_b128 v[32:35], v18 offset:36864
    v_mov_b32 v17, v2
    v_lshrrev_b32 v210, v210, v2
    v_lshrrev_b32 v211, v211, v2
    s_waitcnt lgkmcnt(0)
L_kpre:
    v_mfma_f32_16x16x32_bf16 v[44:47], v[92:95], v[32:35], 0
    v_mfma_f32_16x16x32_bf16 v[48:51], v[96:99], v[32:35], 0
    v_mfma_f32_16x16x32_bf16 v[52:55], v[100:103], v[32:35], 0
    v_mfma_f32_16x16x32_bf16 v[56:59], v[104:107], v[32:35], 0
    v_readlane_b32 s52, v10, s41
    s_add_u32 s41, s41, 1
    s_nop 0
    s_nop 1
    v_add_f32_dpp v4, v45, v44 quad_perm:[1,1,1,1] row_mask:0xf bank_mask:0xf
    v_add_f32_dpp v5, v49, v48 quad_perm:[1,1,1,1] row_mask:0xf bank_mask:0xf
    v_add_f32_dpp v6, v53, v52 quad_perm:[1,1,1,1] row_mask:0xf bank_mask:0xf
    v_add_f32_dpp v7, v57, v56 quad_perm:[1,1,1,1] row_mask:0xf bank_mask:0xf
    v_add_f32_dpp v4, v46, v4 quad_perm:[2,2,2,2] row_mask:0xf bank_mask:0xf
    v_add_f32_dpp v5, v50, v5 quad_perm:[2,2,2,2] row_mask:0xf bank_mask:0xf
    v_add_f32_dpp v6, v54, v6 quad_perm:[2,2,2,2] row_mask:0xf bank_mask:0xf
    v_add_f32_dpp v7, v58, v7 quad_perm:[2,2,2,2] row_mask:0xf bank_mask:0xf
    v_add_f32_dpp v4, v47, v4 quad_perm:[3,3,3,3] row_mask:0xf bank_mask:0xf
    v_add_f32_dpp v5, v51, v5 quad_perm:[3,3,3,3] row_mask:0xf bank_mask:0xf
    v_add_f32_dpp v6, v55, v6 quad_perm:[3,3,3,3] row_mask:0xf bank_mask:0xf
    v_add_f32_dpp v7, v59, v7 quad_perm:[3,3,3,3] row_mask:0xf bank_mask:0xf
    s_mov_b64 exec, s[98:99]
    v_max3_f32 v20, v4, v5, v20
    ds_write_b128 v12, v[4:7] offset:1024
    v_max3_f32 v20, v6, v7, v20
    s_mov_b64 exec, s[96:97]
    s_cbranch_execz L_g1
    s_waitcnt vmcnt(4)
    buffer_load_dwordx4 v[92:95], v18, s[44:47], s52 offen offset:0 nt
    s_bitset1_b32 s52, 15
    s_waitcnt vmcnt(4)
    buffer_load_dwordx4 v[100:103], v18, s[44:47], s52 offen offset:0 nt
L_g1:
    v_mfma_f32_16x16x32_bf16 v[44:47], v[124:127], v[32:35], 0
    v_mfma_f32_16x16x32_bf16 v[48:51], v[128:131], v[32:35], 0
    v_mfma_f32_16x16x32_bf16 v[52:55], v[132:135], v[32:35], 0
    v_mfma_f32_16x16x32_bf16 v[56:59], v[136:139], v[32:35], 0
    s_nop 0
    s_nop 3
    v_add_f32_dpp v4, v45, v44 quad_perm:[1,1,1,1] row_mask:0xf bank_mask:0xf
    v_add_f32_dpp v5, v49, v48 quad_perm:[1,1,1,1] row_mask:0xf bank_mask:0xf
    v_add_f32_dpp v6, v53, v52 quad_perm:[1,1,1,1] row_mask:0xf bank_mask:0xf
    v_add_f32_dpp v7, v57, v56 quad_perm:[1,1,1,1] row_mask:0xf bank_mask:0xf
    v_add_f32_dpp v4, v46, v4 quad_perm:[2,2,2,2] row_mask:0xf bank_mask:0xf
    v_add_f32_dpp v5, v50, v5 quad_perm:[2,2,2,2] row_mask:0xf bank_mask:0xf
    v_add_f32_dpp v6, v54, v6 quad_perm:[2,2,2,2] row_mask:0xf bank_mask:0xf
    v_add_f32_dpp v7, v58, v7 quad_perm:[2,2,2,2] row_mask:0xf bank_mask:0xf
    v_add_f32_dpp v4, v47, v4 quad_perm:[3,3,3,3] row_mask:0xf bank_mask:0xf
    v_add_f32_dpp v5, v51, v5 quad_perm:[3,3,3,3] row_mask:0xf bank_mask:0xf
    v_add_f32_dpp v6, v55, v6 quad_perm:[3,3,3,3] row_mask:0xf bank_mask:0xf
    v_add_f32_dpp v7, v59, v7 quad_perm:[3,3,3,3] row_mask:0xf bank_mask:0xf
    s_mov_b64 exec, s[98:99]
    v_max3_f32 v20, v4, v5, v20
    ds_write_b128 v12, v[4:7] offset:0
    v_max3_f32 v20, v6, v7, v20
    s_mov_b64 exec, s[96:97]
    s_cbranch_execz L_g2
    s_bitset0_b32 s52, 15
    s_waitcnt vmcnt(4)
    buffer_load_dwordx4 v[96:99], v18, s[44:47], s52 offen offset:1024 nt
    s_bitset1_b32 s52, 15
    s_waitcnt vmcnt(4)
    buffer_load_dwordx4 v[104:107], v18, s[44:47], s52 offen offset:1024 nt
L_g2:
    v_mfma_f32_16x16x32_bf16 v[44:47], v[76:79], v[32:35], 0
    v_mfma_f32_16x16x32_bf16 v[48:51], v[80:83], v[32:35], 0
    v_mfma_f32_16x16x32_bf16 v[52:55], v[84:87], v[32:35], 0
    v_mfma_f32_16x16x32_bf16 v[56:59], v[88:91], v[32:35], 0
    v_readlane_b32 s52, v10, s41
    s_add_u32 s41, s41, 1
    s_nop 0
    s_nop 1
    v_add_f32_dpp v4, v45, v44 quad_perm:[1,1,1,1] row_mask:0xf bank_mask:0xf
    v_add_f32_dpp v5, v49, v48 quad_perm:[1,1,1,1] row_mask:0xf bank_mask:0xf
    v_add_f32_dpp v6, v53, v52 quad_perm:[1,1,1,1] row_mask:0xf bank_mask:0xf
    v_add_f32_dpp v7, v57, v56 quad_perm:[1,1,1,1] row_mask:0xf bank_mask:0xf
    v_add_f32_dpp v4, v46, v4 quad_perm:[2,2,2,2] row_mask:0xf bank_mask:0xf
    v_add_f32_dpp v5, v50, v5 quad_perm:[2,2,2,2] row_mask:0xf bank_mask:0xf
    v_add_f32_dpp v6, v54, v6 quad_perm:[2,2,2,2] row_mask:0xf bank_mask:0xf
    v_add_f32_dpp v7, v58, v7 quad_perm:[2,2,2,2] row_mask:0xf bank_mask:0xf
    v_add_f32_dpp v4, v47, v4 quad_perm:[3,3,3,3] row_mask:0xf bank_mask:0xf
    v_add_f32_dpp v5, v51, v5 quad_perm:[3,3,3,3] row_mask:0xf bank_mask:0xf
    v_add_f32_dpp v6, v55, v6 quad_perm:[3,3,3,3] row_mask:0xf bank_mask:0xf
    v_add_f32_dpp v7, v59, v7 quad_perm:[3,3,3,3] row_mask:0xf bank_mask:0xf
    s_mov_b64 exec, s[98:99]
    v_max3_f32 v20, v4, v5, v20
    ds_write_b128 v12, v[4:7] offset:1280
    v_max3_f32 v20, v6, v7, v20
    s_mov_b64 exec, s[96:97]
    s_cbranch_execz L_g3
    s_waitcnt vmcnt(4)
    buffer_load_dwordx4 v[76:79], v18, s[44:47], s52 offen offset:0 nt
    s_bitset1_b32 s52, 15
    s_waitcnt vmcnt(4)
    buffer_load_dwordx4 v[84:87], v18, s[44:47], s52 offen offset:0 nt
L_g3:
    v_mfma_f32_16x16x32_bf16 v[44:47], v[140:143], v[32:35], 0
    v_mfma_f32_16x16x32_bf16 v[48:51], v[144:147], v[32:35], 0
    v_mfma_f32_16x16x32_bf16 v[52:55], v[148:151], v[32:35], 0
    v_mfma_f32_16x16x32_bf16 v[56:59], v[152:155], v[32:35], 0
    s_nop 0
    s_nop 3
    v_add_f32_dpp v4, v45, v44 quad_perm:[1,1,1,1] row_mask:0xf bank_mask:0xf
    v_add_f32_dpp v5, v49, v48 quad_perm:[1,1,1,1] row_mask:0xf bank_mask:0xf
    v_add_f32_dpp v6, v53, v52 quad_perm:[1,1,1,1] row_mask:0xf bank_mask:0xf
    v_add_f32_dpp v7, v57, v56 quad_perm:[1,1,1,1] row_mask:0xf bank_mask:0xf
    v_add_f32_dpp v4, v46, v4 quad_perm:[2,2,2,2] row_mask:0xf bank_mask:0xf
    v_add_f32_dpp v5, v50, v5 quad_perm:[2,2,2,2] row_mask:0xf bank_mask:0xf
    v_add_f32_dpp v6, v54, v6 quad_perm:[2,2,2,2] row_mask:0xf bank_mask:0xf
    v_add_f32_dpp v7, v58, v7 quad_perm:[2,2,2,2] row_mask:0xf bank_mask:0xf
    v_add_f32_dpp v4, v47, v4 quad_perm:[3,3,3,3] row_mask:0xf bank_mask:0xf
    v_add_f32_dpp v5, v51, v5 quad_perm:[3,3,3,3] row_mask:0xf bank_mask:0xf
    v_add_f32_dpp v6, v55, v6 quad_perm:[3,3,3,3] row_mask:0xf bank_mask:0xf
    v_add_f32_dpp v7, v59, v7 quad_perm:[3,3,3,3] row_mask:0xf bank_mask:0xf
    s_mov_b64 exec, s[98:99]
    v_max3_f32 v20, v4, v5, v20
    ds_write_b128 v12, v[4:7] offset:256
    v_max3_f32 v20, v6, v7, v20
    s_mov_b64 exec, s[96:97]
    s_cbranch_execz L_g4
    s_bitset0_b32 s52, 15
    s_waitcnt vmcnt(4)
    buffer_load_dwordx4 v[80:83], v18, s[44:47], s52 offen offset:1024 nt
    s_bitset1_b32 s52, 15
    s_waitcnt vmcnt(4)
    buffer_load_dwordx4 v[88:91], v18, s[44:47], s52 offen offset:1024 nt
L_g4:
    v_mfma_f32_16x16x32_bf16 v[44:47], v[108:111], v[32:35], 0
    v_mfma_f32_16x16x32_bf16 v[48:51], v[112:115], v[32:35], 0
    v_mfma_f32_16x16x32_bf16 v[52:55], v[116:119], v[32:35], 0
    v_mfma_f32_16x16x32_bf16 v[56:59], v[120:123], v[32:35], 0
    v_readlane_b32 s52, v10, s41
    s_add_u32 s41, s41, 1
    s_nop 0
    s_nop 1
    v_add_f32_dpp v4, v45, v44 quad_perm:[1,1,1,1] row_mask:0xf bank_mask:0xf
    v_add_f32_dpp v5, v49, v48 quad_perm:[1,1,1,1] row_mask:0xf bank_mask:0xf
    v_add_f32_dpp v6, v53, v52 quad_perm:[1,1,1,1] row_mask:0xf bank_mask:0xf
    v_add_f32_dpp v7, v57, v56 quad_perm:[1,1,1,1] row_mask:0xf bank_mask:0xf
    v_add_f32_dpp v4, v46, v4 quad_perm:[2,2,2,2] row_mask:0xf bank_mask:0xf
    v_add_f32_dpp v5, v50, v5 quad_perm:[2,2,2,2] row_mask:0xf bank_mask:0xf
    v_add_f32_dpp v6, v54, v6 quad_perm:[2,2,2,2] row_mask:0xf bank_mask:0xf
    v_add_f32_dpp v7, v58, v7 quad_perm:[2,2,2,2] row_mask:0xf bank_mask:0xf
    v_add_f32_dpp v4, v47, v4 quad_perm:[3,3,3,3] row_mask:0xf bank_mask:0xf
    v_add_f32_dpp v5, v51, v5 quad_perm:[3,3,3,3] row_mask:0xf bank_mask:0xf
    v_add_f32_dpp v6, v55, v6 quad_perm:[3,3,3,3] row_mask:0xf bank_mask:0xf
    v_add_f32_dpp v7, v59, v7 quad_perm:[3,3,3,3] row_mask:0xf bank_mask:0xf
    s_mov_b64 exec, s[98:99]
    v_max3_f32 v20, v4, v5, v20
    ds_write_b128 v12, v[4:7] offset:1536
    v_max3_f32 v20, v6, v7, v20
    s_mov_b64 exec, s[96:97]
    s_cbranch_execz L_g5
    s_waitcnt vmcnt(4)
    buffer_load_dwordx4 v[108:111], v18, s[44:47], s52 offen offset:0 nt
    s_bitset1_b32 s52, 15
    s_waitcnt vmcnt(4)
    buffer_load_dwordx4 v[116:119], v18, s[44:47], s52 offen offset:0 nt
L_g5:
    v_mfma_f32_16x16x32_bf16 v[44:47], v[156:159], v[32:35], 0
    v_mfma_f32_16x16x32_bf16 v[48:51], v[160:163], v[32:35], 0
    v_mfma_f32_16x16x32_bf16 v[52:55], v[164:167], v[32:35], 0
    v_mfma_f32_16x16x32_bf16 v[56:59], v[168:171], v[32:35], 0
    s_nop 0
    s_nop 3
    v_add_f32_dpp v4, v45, v44 quad_perm:[1,1,1,1] row_mask:0xf bank_mask:0xf
    v_add_f32_dpp v5, v49, v48 quad_perm:[1,1,1,1] row_mask:0xf bank_mask:0xf
    v_add_f32_dpp v6, v53, v52 quad_perm:[1,1,1,1] row_mask:0xf bank_mask:0xf
    v_add_f32_dpp v7, v57, v56 quad_perm:[1,1,1,1] row_mask:0xf bank_mask:0xf
    v_add_f32_dpp v4, v46, v4 quad_perm:[2,2,2,2] row_mask:0xf bank_mask:0xf
    v_add_f32_dpp v5, v50, v5 quad_perm:[2,2,2,2] row_mask:0xf bank_mask:0xf
    v_add_f32_dpp v6, v54, v6 quad_perm:[2,2,2,2] row_mask:0xf bank_mask:0xf
    v_add_f32_dpp v7, v58, v7 quad_perm:[2,2,2,2] row_mask:0xf bank_mask:0xf
    v_add_f32_dpp v4, v47, v4 quad_perm:[3,3,3,3] row_mask:0xf bank_mask:0xf
    v_add_f32_dpp v5, v51, v5 quad_perm:[3,3,3,3] row_mask:0xf bank_mask:0xf
    v_add_f32_dpp v6, v55, v6 quad_perm:[3,3,3,3] row_mask:0xf bank_mask:0xf
    v_add_f32_dpp v7, v59, v7 quad_perm:[3,3,3,3] row_mask:0xf bank_mask:0xf
    s_mov_b64 exec, s[98:99]
    v_max3_f32 v20, v4, v5, v20
    ds_write_b128 v12, v[4:7] offset:512
    v_max3_f32 v20, v6, v7, v20
    s_mov_b64 exec, s[96:97]
    s_cbranch_execz L_g6
    s_bitset0_b32 s52, 15
    s_waitcnt vmcnt(4)
    buffer_load_dwordx4 v[112:115], v18, s[44:47], s52 offen offset:1024 nt
    s_bitset1_b32 s52, 15
    s_waitcnt vmcnt(4)
    buffer_load_dwordx4 v[120:123], v18, s[44:47], s52 offen offset:1024 nt
L_g6:
    v_mfma_f32_16x16x32_bf16 v[44:47], v[60:63], v[32:35], 0
    v_mfma_f32_16x16x32_bf16 v[48:51], v[64:67], v[32:35], 0
    v_mfma_f32_16x16x32_bf16 v[52:55], v[68:71], v[32:35], 0
    v_mfma_f32_16x16x32_bf16 v[56:59], v[72:75], v[32:35], 0
    v_readlane_b32 s52, v10, s41
    s_add_u32 s41, s41, 1
    s_nop 0
    s_nop 1
    v_add_f32_dpp v4, v45, v44 quad_perm:[1,1,1,1] row_mask:0xf bank_mask:0xf
    v_add_f32_dpp v5, v49, v48 quad_perm:[1,1,1,1] row_mask:0xf bank_mask:0xf
    v_add_f32_dpp v6, v53, v52 quad_perm:[1,1,1,1] row_mask:0xf bank_mask:0xf
    v_add_f32_dpp v7, v57, v56 quad_perm:[1,1,1,1] row_mask:0xf bank_mask:0xf
    v_add_f32_dpp v4, v46, v4 quad_perm:[2,2,2,2] row_mask:0xf bank_mask:0xf
    v_add_f32_dpp v5, v50, v5 quad_perm:[2,2,2,2] row_mask:0xf bank_mask:0xf
    v_add_f32_dpp v6, v54, v6 quad_perm:[2,2,2,2] row_mask:0xf bank_mask:0xf
    v_add_f32_dpp v7, v58, v7 quad_perm:[2,2,2,2] row_mask:0xf bank_mask:0xf
    v_add_f32_dpp v4, v47, v4 quad_perm:[3,3,3,3] row_mask:0xf bank_mask:0xf
    v_add_f32_dpp v5, v51, v5 quad_perm:[3,3,3,3] row_mask:0xf bank_mask:0xf
    v_add_f32_dpp v6, v55, v6 quad_perm:[3,3,3,3] row_mask:0xf bank_mask:0xf
    v_add_f32_dpp v7, v59, v7 quad_perm:[3,3,3,3] row_mask:0xf bank_mask:0xf
    s_mov_b64 exec, s[98:99]
    v_max3_f32 v20, v4, v5, v20
    ds_write_b128 v12, v[4:7] offset:1792
    v_max3_f32 v20, v6, v7, v20
    s_mov_b64 exec, s[96:97]
    s_cbranch_execz L_g7
    s_waitcnt vmcnt(4)
    buffer_load_dwordx4 v[60:63], v18, s[44:47], s52 offen offset:0 nt
    s_bitset1_b32 s52, 15
    s_waitcnt vmcnt(4)
    buffer_load_dwordx4 v[68:71], v18, s[44:47], s52 offen offset:0 nt
L_g7:
    v_mfma_f32_16x16x32_bf16 v[44:47], v[172:175], v[32:35], 0
    v_mfma_f32_16x16x32_bf16 v[48:51], v[176:179], v[32:35], 0
    v_mfma_f32_16x16x32_bf16 v[52:55], v[180:183], v[32:35], 0
    v_mfma_f32_16x16x32_bf16 v[56:59], v[184:187], v[32:35], 0
    s_nop 0
    s_nop 3
    v_add_f32_dpp v4, v45, v44 quad_perm:[1,1,1,1] row_mask:0xf bank_mask:0xf
    v_add_f32_dpp v5, v49, v48 quad_perm:[1,1,1,1] row_mask:0xf bank_mask:0xf
    v_add_f32_dpp v6, v53, v52 quad_perm:[1,1,1,1] row_mask:0xf bank_mask:0xf
    v_add_f32_dpp v7, v57, v56 quad_perm:[1,1,1,1] row_mask:0xf bank_mask:0xf
    v_add_f32_dpp v4, v46, v4 quad_perm:[2,2,2,2] row_mask:0xf bank_mask:0xf
    v_add_f32_dpp v5, v50, v5 quad_perm:[2,2,2,2] row_mask:0xf bank_mask:0xf
    v_add_f32_dpp v6, v54, v6 quad_perm:[2,2,2,2] row_mask:0xf bank_mask:0xf
    v_add_f32_dpp v7, v58, v7 quad_perm:[2,2,2,2] row_mask:0xf bank_mask:0xf
    v_add_f32_dpp v4, v47, v4 quad_perm:[3,3,3,3] row_mask:0xf bank_mask:0xf
    v_add_f32_dpp v5, v51, v5 quad_perm:[3,3,3,3] row_mask:0xf bank_mask:0xf
    v_add_f32_dpp v6, v55, v6 quad_perm:[3,3,3,3] row_mask:0xf bank_mask:0xf
    v_add_f32_dpp v7, v59, v7 quad_perm:[3,3,3,3] row_mask:0xf bank_mask:0xf
    s_mov_b64 exec, s[98:99]
    v_max3_f32 v20, v4, v5, v20
    ds_write_b128 v12, v[4:7] offset:768
    v_max3_f32 v20, v6, v7, v20
    s_mov_b64 exec, s[96:97]
    s_cbranch_execz L_g8
    s_bitset0_b32 s52, 15
    s_waitcnt vmcnt(4)
    buffer_load_dwordx4 v[64:67], v18, s[44:47], s52 offen offset:1024 nt
    s_bitset1_b32 s52, 15
    s_waitcnt vmcnt(4)
    buffer_load_dwordx4 v[72:75], v18, s[44:47], s52 offen offset:1024 nt
L_g8:
    v_add_u32 v12, 2048, v12
.p2align 6
L_kloop:
    s_cmp_lg_u32 s76, 0
    s_cbranch_scc1 L_k0
    v_readlane_b32 s52, v10, s41
    s_mov_b64 s[72:73], s[8:9]
    v_mov_b32 v11, v19
    s_mov_b32 s41, 0
    s_cbranch_execz L_g9
    s_waitcnt vmcnt(4)
    buffer_load_dwordx4 v[172:175], v18, s[44:47], s52 offen offset:0 nt
    s_bitset1_b32 s52, 15
    s_waitcnt vmcnt(4)
    buffer_load_dwordx4 v[180:183], v18, s[44:47], s52 offen offset:0 nt
    s_bitset0_b32 s52, 15
    s_waitcnt vmcnt(4)
    buffer_load_dwordx4 v[176:179], v18, s[44:47], s52 offen offset:1024 nt
    s_bitset1_b32 s52, 15
    s_waitcnt vmcnt(4)
    buffer_load_dwordx4 v[184:187], v18, s[44:47], s52 offen offset:1024 nt
L_g9:
L_k0:
    v_mfma_f32_16x16x32_bf16 v[44:47], v[92:95], v[32:35], 0
    v_mfma_f32_16x16x32_bf16 v[48:51], v[96:99], v[32:35], 0
    v_mfma_f32_16x16x32_bf16 v[52:55], v[100:103], v[32:35], 0
    v_mfma_f32_16x16x32_bf16 v[56:59], v[104:107], v[32:35], 0
    v_readlane_b32 s52, v10, s41
    s_add_u32 s41, s41, 1
    s_nop 0
    s_nop 1
    v_add_f32_dpp v4, v45, v44 quad_perm:[1,1,1,1] row_mask:0xf bank_mask:0xf
    v_add_f32_dpp v5, v49, v48 quad_perm:[1,1,1,1] row_mask:0xf bank_mask:0xf
    v_add_f32_dpp v6, v53, v52 quad_perm:[1,1,1,1] row_mask:0xf bank_mask:0xf
    v_add_f32_dpp v7, v57, v56 quad_perm:[1,1,1,1] row_mask:0xf bank_mask:0xf
    v_add_f32_dpp v4, v46, v4 quad_perm:[2,2,2,2] row_mask:0xf bank_mask:0xf
    v_add_f32_dpp v5, v50, v5 quad_perm:[2,2,2,2] row_mask:0xf bank_mask:0xf
    v_add_f32_dpp v6, v54, v6 quad_perm:[2,2,2,2] row_mask:0xf bank_mask:0xf
    v_add_f32_dpp v7, v58, v7 quad_perm:[2,2,2,2] row_mask:0xf bank_mask:0xf
    v_add_f32_dpp v4, v47, v4 quad_perm:[3,3,3,3] row_mask:0xf bank_mask:0xf
    v_add_f32_dpp v5, v51, v5 quad_perm:[3,3,3,3] row_mask:0xf bank_mask:0xf
    v_add_f32_dpp v6, v55, v6 quad_perm:[3,3,3,3] row_mask:0xf bank_mask:0xf
    v_add_f32_dpp v7, v59, v7 quad_perm:[3,3,3,3] row_mask:0xf bank_mask:0xf
    s_mov_b64 exec, s[98:99]
    v_max3_f32 v20, v4, v5, v20
    ds_write_b128 v12, v[4:7] offset:0
    v_max3_f32 v20, v6, v7, v20
    s_mov_b64 exec, s[96:97]
    s_cbranch_execz L_g10
    s_waitcnt vmcnt(4)
    buffer_load_dwordx4 v[92:95], v11, s[72:75], s52 offen offset:0 nt
    s_bitset1_b32 s52, 15
    s_waitcnt vmcnt(4)
    buffer_load_dwordx4 v[100:103], v11, s[72:75], s52 offen offset:0 nt
    s_bitset0_b32 s52, 15
    s_waitcnt vmcnt(4)
    buffer_load_dwordx4 v[96:99], v11, s[72:75], s52 offen offset:1024 nt
    s_bitset1_b32 s52, 15
    s_waitcnt vmcnt(4)
    buffer_load_dwordx4 v[104:107], v11, s[72:75], s52 offen offset:1024 nt
L_g10:
    v_mfma_f32_16x16x32_bf16 v[44:47], v[76:79], v[32:35], 0
    v_mfma_f32_16x16x32_bf16 v[48:51], v[80:83], v[32:35], 0
    v_mfma_f32_16x16x32_bf16 v[52:55], v[84:87], v[32:35], 0
    v_mfma_f32_16x16x32_bf16 v[56:59], v[88:91], v[32:35], 0
    v_readlane_b32 s52, v10, s41
    s_add_u32 s41, s41, 1
    s_nop 2
    v_add_f32_dpp v4, v45, v44 quad_perm:[1,1,1,1] row_mask:0xf bank_mask:0xf
    v_add_f32_dpp v5, v49, v48 quad_perm:[1,1,1,1] row_mask:0xf bank_mask:0xf
    v_add_f32_dpp v6, v53, v52 quad_perm:[1,1,1,1] row_mask:0xf bank_mask:0xf
    v_add_f32_dpp v7, v57, v56 quad_perm:[1,1,1,1] row_mask:0xf bank_mask:0xf
    v_add_f32_dpp v4, v46, v4 quad_perm:[2,2,2,2] row_mask:0xf bank_mask:0xf
    v_add_f32_dpp v5, v50, v5 quad_perm:[2,2,2,2] row_mask:0xf bank_mask:0xf
    v_add_f32_dpp v6, v54, v6 quad_perm:[2,2,2,2] row_mask:0xf bank_mask:0xf
    v_add_f32_dpp v7, v58, v7 quad_perm:[2,2,2,2] row_mask:0xf bank_mask:0xf
    v_add_f32_dpp v4, v47, v4 quad_perm:[3,3,3,3] row_mask:0xf bank_mask:0xf
    v_add_f32_dpp v5, v51, v5 quad_perm:[3,3,3,3] row_mask:0xf bank_mask:0xf
    v_add_f32_dpp v6, v55, v6 quad_perm:[3,3,3,3] row_mask:0xf bank_mask:0xf
    v_add_f32_dpp v7, v59, v7 quad_perm:[3,3,3,3] row_mask:0xf bank_mask:0xf
    s_mov_b64 exec, s[98:99]
    v_max3_f32 v20, v4, v5, v20
    ds_write_b128 v12, v[4:7] offset:256
    v_max3_f32 v20, v6, v7, v20
    s_mov_b64 exec, s[96:97]
    s_cbranch_execz L_g11
    s_waitcnt vmcnt(4)
    buffer_load_dwordx4 v[76:79], v11, s[72:75], s52 offen offset:0 nt
    s_bitset1_b32 s52, 15
    s_waitcnt vmcnt(4)
    buffer_load_dwordx4 v[84:87], v11, s[72:75], s52 offen offset:0 nt
    s_bitset0_b32 s52, 15
    s_waitcnt vmcnt(4)
    buffer_load_dwordx4 v[80:83], v11, s[72:75], s52 offen offset:1024 nt
    s_bitset1_b32 s52, 15
    s_waitcnt vmcnt(4)
    buffer_load_dwordx4 v[88:91], v11, s[72:75], s52 offen offset:1024 nt
L_g11:
    v_mfma_f32_16x16x32_bf16 v[44:47], v[108:111], v[32:35], 0
    v_mfma_f32_16x16x32_bf16 v[48:51], v[112:115], v[32:35], 0
    v_mfma_f32_16x16x32_bf16 v[52:55], v[116:119], v[32:35], 0
    v_mfma_f32_16x16x32_bf16 v[56:59], v[120:123], v[32:35], 0
    v_readlane_b32 s52, v10, s41
    s_add_u32 s41, s41, 1
    s_nop 2
    v_add_f32_dpp v4, v45, v44 quad_perm:[1,1,1,1] row_mask:0xf bank_mask:0xf
    v_add_f32_dpp v5, v49, v48 quad_perm:[1,1,1,1] row_mask:0xf bank_mask:0xf
    v_add_f32_dpp v6, v53, v52 quad_perm:[1,1,1,1] row_mask:0xf bank_mask:0xf
    v_add_f32_dpp v7, v57, v56 quad_perm:[1,1,1,1] row_mask:0xf bank_mask:0xf
    v_add_f32_dpp v4, v46, v4 quad_perm:[2,2,2,2] row_mask:0xf bank_mask:0xf
    v_add_f32_dpp v5, v50, v5 quad_perm:[2,2,2,2] row_mask:0xf bank_mask:0xf
    v_add_f32_dpp v6, v54, v6 quad_perm:[2,2,2,2] row_mask:0xf bank_mask:0xf
    v_add_f32_dpp v7, v58, v7 quad_perm:[2,2,2,2] row_mask:0xf bank_mask:0xf
    v_add_f32_dpp v4, v47, v4 quad_perm:[3,3,3,3] row_mask:0xf bank_mask:0xf
    v_add_f32_dpp v5, v51, v5 quad_perm:[3,3,3,3] row_mask:0xf bank_mask:0xf
    v_add_f32_dpp v6, v55, v6 quad_perm:[3,3,3,3] row_mask:0xf bank_mask:0xf
    v_add_f32_dpp v7, v59, v7 quad_perm:[3,3,3,3] row_mask:0xf bank_mask:0xf
    s_mov_b64 exec, s[98:99]
    v_max3_f32 v20, v4, v5, v20
    ds_write_b128 v12, v[4:7] offset:512
    v_max3_f32 v20, v6, v7, v20
    s_mov_b64 exec, s[96:97]
    s_cbranch_execz L_g12
    s_waitcnt vmcnt(4)
    buffer_load_dwordx4 v[108:111], v11, s[72:75], s52 offen offset:0 nt
    s_bitset1_b32 s52, 15
    s_waitcnt vmcnt(4)
    buffer_load_dwordx4 v[116:119], v11, s[72:75], s52 offen offset:0 nt
    s_bitset0_b32 s52, 15
    s_waitcnt vmcnt(4)
    buffer_load_dwordx4 v[112:115], v11, s[72:75], s52 offen offset:1024 nt
    s_bitset1_b32 s52, 15
    s_waitcnt vmcnt(4)
    buffer_load_dwordx4 v[120:123], v11, s[72:75], s52 offen offset:1024 nt
L_g12:
    v_mfma_f32_16x16x32_bf16 v[44:47], v[60:63], v[32:35], 0
    v_mfma_f32_16x16x32_bf16 v[48:51], v[64:67], v[32:35], 0
    v_mfma_f32_16x16x32_bf16 v[52:55], v[68:71], v[32:35], 0
    v_mfma_f32_16x16x32_bf16 v[56:59], v[72:75], v[32:35], 0
    v_readlane_b32 s52, v10, s41
    s_add_u32 s41, s41, 1
    s_nop 2
    v_add_f32_dpp v4, v45, v44 quad_perm:[1,1,1,1] row_mask:0xf bank_mask:0xf
    v_add_f32_dpp v5, v49, v48 quad_perm:[1,1,1,1] row_mask:0xf bank_mask:0xf
    v_add_f32_dpp v6, v53, v52 quad_perm:[1,1,1,1] row_mask:0xf bank_mask:0xf
    v_add_f32_dpp v7, v57, v56 quad_perm:[1,1,1,1] row_mask:0xf bank_mask:0xf
    v_add_f32_dpp v4, v46, v4 quad_perm:[2,2,2,2] row_mask:0xf bank_mask:0xf
    v_add_f32_dpp v5, v50, v5 quad_perm:[2,2,2,2] row_mask:0xf bank_mask:0xf
    v_add_f32_dpp v6, v54, v6 quad_perm:[2,2,2,2] row_mask:0xf bank_mask:0xf
    v_add_f32_dpp v7, v58, v7 quad_perm:[2,2,2,2] row_mask:0xf bank_mask:0xf
    v_add_f32_dpp v4, v47, v4 quad_perm:[3,3,3,3] row_mask:0xf bank_mask:0xf
    v_add_f32_dpp v5, v51, v5 quad_perm:[3,3,3,3] row_mask:0xf bank_mask:0xf
    v_add_f32_dpp v6, v55, v6 quad_perm:[3,3,3,3] row_mask:0xf bank_mask:0xf
    v_add_f32_dpp v7, v59, v7 quad_perm:[3,3,3,3] row_mask:0xf bank_mask:0xf
    s_mov_b64 exec, s[98:99]
    v_max3_f32 v20, v4, v5, v20
    ds_write_b128 v12, v[4:7] offset:768
    v_max3_f32 v20, v6, v7, v20
    s_mov_b64 exec, s[96:97]
    s_cbranch_execz L_g13
    s_waitcnt vmcnt(4)
    buffer_load_dwordx4 v[60:63], v11, s[72:75], s52 offen offset:0 nt
    s_bitset1_b32 s52, 15
    s_waitcnt vmcnt(4)
    buffer_load_dwordx4 v[68:71], v11, s[72:75], s52 offen offset:0 nt
    s_bitset0_b32 s52, 15
    s_waitcnt vmcnt(4)
    buffer_load_dwordx4 v[64:67], v11, s[72:75], s52 offen offset:1024 nt
    s_bitset1_b32 s52, 15
    s_waitcnt vmcnt(4)
    buffer_load_dwordx4 v[72:75], v11, s[72:75], s52 offen offset:1024 nt
L_g13:
    v_add_u32 v12, 1024, v12
    s_sub_u32 s76, s76, 1
    s_cbranch_scc0 L_kloop
    ds_read_b32 v9, v16 offset:0
    v_mov_b32_dpp v1, v20 quad_perm:[0,0,0,0] row_mask:0xf bank_mask:0xf
    v_mov_b32_dpp v2, v20 quad_perm:[0,0,0,0] row_mask:0xf bank_mask:0xf
    s_mov_b32 s78, 1
    s_nop 0
    v_permlane16_swap_b32 v1, v2
    s_nop 0
    v_max_f32 v1, v1, v2
    v_mov_b32 v2, v1
    s_nop 1
    v_permlane32_swap_b32 v1, v2
    s_nop 0
    v_max_f32 v20, v1, v2
    v_cvt_pk_bf16_f32 v20, v20, v20
    v_and_b32 v20, s67, v20
    v_mul_f32 v20, s43, v20
    v_cvt_pk_bf16_f32 v20, v20, v20
    v_and_b32 v20, s67, v20
    v_mul_f32 v3, s53, v20
.p2align 6
L_vloop:
    s_cmp_lg_u32 s77, 0
    s_cbranch_scc1 L_v0
    s_mov_b32 s78, 0
    s_cbranch_execz L_g14
    s_mov_b32 s35, 1
    s_mov_b64 exec, 1
    v_mov_b32 v15, s35
    ds_write_b32 v14, v15 offset:38176
    s_mov_b64 exec, -1
L_g14:
L_v0:
    v_readlane_b32 s52, v10, s41
    s_waitcnt lgkmcnt(0)
    v_cvt_pk_bf16_f32 v4, v9, v9
    v_and_b32 v4, s67, v4
    v_mul_f32 v4, s43, v4
    v_cvt_pk_bf16_f32 v4, v4, v4
    v_and_b32 v4, s67, v4
    v_fma_f32 v4, v4, s53, -v3
    ds_read_b32 v9, v16 offset:256
    v_exp_f32 v4, v4
    s_add_u32 s41, s41, s78
    v_cvt_pk_bf16_f32 v5, v4, v4
    v_add_f32 v21, v21, v4
    s_nop 0
    v_and_b32_dpp v24, v5, v22 quad_perm:[0,0,0,0] row_mask:0xf bank_mask:0xf
    v_and_b32_dpp v25, v5, v23 quad_perm:[0,0,0,0] row_mask:0xf bank_mask:0xf
    v_and_b32_dpp v26, v5, v22 quad_perm:[1,1,1,1] row_mask:0xf bank_mask:0xf
    v_and_b32_dpp v27, v5, v23 quad_perm:[1,1,1,1] row_mask:0xf bank_mask:0xf
    v_and_b32_dpp v28, v5, v22 quad_perm:[2,2,2,2] row_mask:0xf bank_mask:0xf
    v_and_b32_dpp v29, v5, v23 quad_perm:[2,2,2,2] row_mask:0xf bank_mask:0xf
    v_and_b32_dpp v30, v5, v22 quad_perm:[3,3,3,3] row_mask:0xf bank_mask:0xf
    v_and_b32_dpp v31, v5, v23 quad_perm:[3,3,3,3] row_mask:0xf bank_mask:0xf
    v_mfma_f32_16x16x16_bf16 v[36:39], v[24:25], v[92:93], v[36:39]
    v_mfma_f32_16x16x16_bf16 v[40:43], v[24:25], v[94:95], v[40:43]
    v_mfma_f32_16x16x16_bf16 v[36:39], v[26:27], v[96:97], v[36:39]
    v_mfma_f32_16x16x16_bf16 v[40:43], v[26:27], v[98:99], v[40:43]
    v_mfma_f32_16x16x16_bf16 v[36:39], v[28:29], v[100:101], v[36:39]
    v_mfma_f32_16x16x16_bf16 v[40:43], v[28:29], v[102:103], v[40:43]
    v_mfma_f32_16x16x16_bf16 v[36:39], v[30:31], v[104:105], v[36:39]
    v_mfma_f32_16x16x16_bf16 v[40:43], v[30:31], v[106:107], v[40:43]
    s_cmp_eq_u32 s77, 0
    s_cbranch_scc1 L_vs0
    s_waitcnt vmcnt(4)
    buffer_load_dwordx4 v[92:95], v19, s[48:51], s52 offen offset:0 nt
    s_bitset1_b32 s52, 15
    s_waitcnt vmcnt(4)
    buffer_load_dwordx4 v[100:103], v19, s[48:51], s52 offen offset:0 nt
    s_bitset0_b32 s52, 15
    s_waitcnt vmcnt(4)
    buffer_load_dwordx4 v[96:99], v19, s[48:51], s52 offen offset:1024 nt
    s_bitset1_b32 s52, 15
    s_waitcnt vmcnt(4)
    buffer_load_dwordx4 v[104:107], v19, s[48:51], s52 offen offset:1024 nt
L_vs0:
    v_readlane_b32 s52, v10, s41
    s_waitcnt lgkmcnt(0)
    v_cvt_pk_bf16_f32 v4, v9, v9
    v_and_b32 v4, s67, v4
    v_mul_f32 v4, s43, v4
    v_cvt_pk_bf16_f32 v4, v4, v4
    v_and_b32 v4, s67, v4
    v_fma_f32 v4, v4, s53, -v3
    ds_read_b32 v9, v16 offset:512
    v_exp_f32 v4, v4
    s_add_u32 s41, s41, 1
    v_cvt_pk_bf16_f32 v5, v4, v4
    v_add_f32_e64 v21, v21, v4
    s_nop 0
    v_and_b32_dpp v24, v5, v22 quad_perm:[0,0,0,0] row_mask:0xf bank_mask:0xf
    v_and_b32_dpp v25, v5, v23 quad_perm:[0,0,0,0] row_mask:0xf bank_mask:0xf
    v_and_b32_dpp v26, v5, v22 quad_perm:[1,1,1,1] row_mask:0xf bank_mask:0xf
    v_and_b32_dpp v27, v5, v23 quad_perm:[1,1,1,1] row_mask:0xf bank_mask:0xf
    v_and_b32_dpp v28, v5, v22 quad_perm:[2,2,2,2] row_mask:0xf bank_mask:0xf
    v_and_b32_dpp v29, v5, v23 quad_perm:[2,2,2,2] row_mask:0xf bank_mask:0xf
    v_and_b32_dpp v30, v5, v22 quad_perm:[3,3,3,3] row_mask:0xf bank_mask:0xf
    v_and_b32_dpp v31, v5, v23 quad_perm:[3,3,3,3] row_mask:0xf bank_mask:0xf
    v_mfma_f32_16x16x16_bf16 v[36:39], v[24:25], v[76:77], v[36:39]
    v_mfma_f32_16x16x16_bf16 v[40:43], v[24:25], v[78:79], v[40:43]
    v_mfma_f32_16x16x16_bf16 v[36:39], v[26:27], v[80:81], v[36:39]
    v_mfma_f32_16x16x16_bf16 v[40:43], v[26:27], v[82:83], v[40:43]
    v_mfma_f32_16x16x16_bf16 v[36:39], v[28:29], v[84:85], v[36:39]
    v_mfma_f32_16x16x16_bf16 v[40:43], v[28:29], v[86:87], v[40:43]
    v_mfma_f32_16x16x16_bf16 v[36:39], v[30:31], v[88:89], v[36:39]
    v_mfma_f32_16x16x16_bf16 v[40:43], v[30:31], v[90:91], v[40:43]
    s_cbranch_execz L_g15
    s_waitcnt vmcnt(4)
    buffer_load_dwordx4 v[76:79], v19, s[48:51], s52 offen offset:0 nt
    s_bitset1_b32 s52, 15
    s_waitcnt vmcnt(4)
    buffer_load_dwordx4 v[84:87], v19, s[48:51], s52 offen offset:0 nt
    s_bitset0_b32 s52, 15
    s_waitcnt vmcnt(4)
    buffer_load_dwordx4 v[80:83], v19, s[48:51], s52 offen offset:1024 nt
    s_bitset1_b32 s52, 15
    s_waitcnt vmcnt(4)
    buffer_load_dwordx4 v[88:91], v19, s[48:51], s52 offen offset:1024 nt
L_g15:
    v_readlane_b32 s52, v10, s41
    s_waitcnt lgkmcnt(0)
    v_cvt_pk_bf16_f32 v4, v9, v9
    v_and_b32 v4, s67, v4
    v_mul_f32 v4, s43, v4
    v_cvt_pk_bf16_f32 v4, v4, v4
    v_and_b32 v4, s67, v4
    v_fma_f32 v4, v4, s53, -v3
    ds_read_b32 v9, v16 offset:768
    v_exp_f32 v4, v4
    s_add_u32 s41, s41, s78
    v_cvt_pk_bf16_f32 v5, v4, v4
    v_add_f32 v21, v21, v4
    s_nop 0
    v_and_b32_dpp v24, v5, v22 quad_perm:[0,0,0,0] row_mask:0xf bank_mask:0xf
    v_and_b32_dpp v25, v5, v23 quad_perm:[0,0,0,0] row_mask:0xf bank_mask:0xf
    v_and_b32_dpp v26, v5, v22 quad_perm:[1,1,1,1] row_mask:0xf bank_mask:0xf
    v_and_b32_dpp v27, v5, v23 quad_perm:[1,1,1,1] row_mask:0xf bank_mask:0xf
    v_and_b32_dpp v28, v5, v22 quad_perm:[2,2,2,2] row_mask:0xf bank_mask:0xf
    v_and_b32_dpp v29, v5, v23 quad_perm:[2,2,2,2] row_mask:0xf bank_mask:0xf
    v_and_b32_dpp v30, v5, v22 quad_perm:[3,3,3,3] row_mask:0xf bank_mask:0xf
    v_and_b32_dpp v31, v5, v23 quad_perm:[3,3,3,3] row_mask:0xf bank_mask:0xf
    v_mfma_f32_16x16x16_bf16 v[36:39], v[24:25], v[108:109], v[36:39]
    v_mfma_f32_16x16x16_bf16 v[40:43], v[24:25], v[110:111], v[40:43]
    v_mfma_f32_16x16x16_bf16 v[36:39], v[26:27], v[112:113], v[36:39]
    v_mfma_f32_16x16x16_bf16 v[40:43], v[26:27], v[114:115], v[40:43]
    v_mfma_f32_16x16x16_bf16 v[36:39], v[28:29], v[116:117], v[36:39]
    v_mfma_f32_16x16x16_bf16 v[40:43], v[28:29], v[118:119], v[40:43]
    v_mfma_f32_16x16x16_bf16 v[36:39], v[30:31], v[120:121], v[36:39]
    v_mfma_f32_16x16x16_bf16 v[40:43], v[30:31], v[122:123], v[40:43]
    s_cmp_eq_u32 s77, 0
    s_cbranch_scc1 L_vs2
    s_waitcnt vmcnt(4)
    buffer_load_dwordx4 v[108:111], v19, s[48:51], s52 offen offset:0 nt
    s_bitset1_b32 s52, 15
    s_waitcnt vmcnt(4)
    buffer_load_dwordx4 v[116:119], v19, s[48:51], s52 offen offset:0 nt
    s_bitset0_b32 s52, 15
    s_waitcnt vmcnt(4)
    buffer_load_dwordx4 v[112:115], v19, s[48:51], s52 offen offset:1024 nt
    s_bitset1_b32 s52, 15
    s_waitcnt vmcnt(4)
    buffer_load_dwordx4 v[120:123], v19, s[48:51], s52 offen offset:1024 nt
L_vs2:
    v_readlane_b32 s52, v10, s41
    s_waitcnt lgkmcnt(0)
    v_cvt_pk_bf16_f32 v4, v9, v9
    v_and_b32 v4, s67, v4
    v_mul_f32 v4, s43, v4
    v_cvt_pk_bf16_f32 v4, v4, v4
    v_and_b32 v4, s67, v4
    v_fma_f32 v4, v4, s53, -v3
    ds_read_b32 v9, v16 offset:1024
    v_exp_f32 v4, v4
    s_add_u32 s41, s41, s78
    v_cvt_pk_bf16_f32 v5, v4, v4
    v_add_f32_e64 v21, v21, v4
    s_nop 0
    v_and_b32_dpp v24, v5, v22 quad_perm:[0,0,0,0] row_mask:0xf bank_mask:0xf
    v_and_b32_dpp v25, v5, v23 quad_perm:[0,0,0,0] row_mask:0xf bank_mask:0xf
    v_and_b32_dpp v26, v5, v22 quad_perm:[1,1,1,1] row_mask:0xf bank_mask:0xf
    v_and_b32_dpp v27, v5, v23 quad_perm:[1,1,1,1] row_mask:0xf bank_mask:0xf
    v_and_b32_dpp v28, v5, v22 quad_perm:[2,2,2,2] row_mask:0xf bank_mask:0xf
    v_and_b32_dpp v29, v5, v23 quad_perm:[2,2,2,2] row_mask:0xf bank_mask:0xf
    v_and_b32_dpp v30, v5, v22 quad_perm:[3,3,3,3] row_mask:0xf bank_mask:0xf
    v_and_b32_dpp v31, v5, v23 quad_perm:[3,3,3,3] row_mask:0xf bank_mask:0xf
    s_cmp_lg_u32 s77, 0
    s_cbranch_scc1 L_vw
    s_waitcnt vmcnt(4)
L_vw:
    v_mfma_f32_16x16x16_bf16 v[36:39], v[24:25], v[60:61], v[36:39]
    v_mfma_f32_16x16x16_bf16 v[40:43], v[24:25], v[62:63], v[40:43]
    v_mfma_f32_16x16x16_bf16 v[36:39], v[26:27], v[64:65], v[36:39]
    v_mfma_f32_16x16x16_bf16 v[40:43], v[26:27], v[66:67], v[40:43]
    v_mfma_f32_16x16x16_bf16 v[36:39], v[28:29], v[68:69], v[36:39]
    v_mfma_f32_16x16x16_bf16 v[40:43], v[28:29], v[70:71], v[40:43]
    v_mfma_f32_16x16x16_bf16 v[36:39], v[30:31], v[72:73], v[36:39]
    v_mfma_f32_16x16x16_bf16 v[40:43], v[30:31], v[74:75], v[40:43]
    s_cmp_eq_u32 s77, 0
    s_cbranch_scc1 L_vs3
    s_waitcnt vmcnt(4)
    buffer_load_dwordx4 v[60:63], v19, s[48:51], s52 offen offset:0 nt
    s_bitset1_b32 s52, 15
    s_waitcnt vmcnt(4)
    buffer_load_dwordx4 v[68:71], v19, s[48:51], s52 offen offset:0 nt
    s_bitset0_b32 s52, 15
    s_waitcnt vmcnt(4)
    buffer_load_dwordx4 v[64:67], v19, s[48:51], s52 offen offset:1024 nt
    s_bitset1_b32 s52, 15
    s_waitcnt vmcnt(4)
    buffer_load_dwordx4 v[72:75], v19, s[48:51], s52 offen offset:1024 nt
L_vs3:
    v_add_u32 v16, 1024, v16
    s_sub_u32 s77, s77, 1
    s_cbranch_scc0 L_vloop
    v_mov_b64 v[60:61], v[172:173]
    v_mov_b64 v[62:63], v[174:175]
    v_mov_b64 v[64:65], v[176:177]
    v_mov_b64 v[66:67], v[178:179]
    v_mov_b64 v[68:69], v[180:181]
    v_mov_b64 v[70:71], v[182:183]
    v_mov_b64 v[72:73], v[184:185]
    v_mov_b64 v[74:75], v[186:187]
    v_add_f32_dpp v21, v21, v21 quad_perm:[1,0,3,2] row_mask:0xf bank_mask:0xf
    s_waitcnt lgkmcnt(0)
    s_nop 0
    v_add_f32_dpp v21, v21, v21 quad_perm:[2,3,0,1] row_mask:0xf bank_mask:0xf
    s_cbranch_execz L_rk0
.p2align 6
L_loop:
    v_readlane_b32 s52, v10, s41
    s_cmp_ge_u32 s41, 29
    s_cbranch_scc1 L_tk0
    s_nop 1
L_gk0:
    s_waitcnt vmcnt(4)
    buffer_load_dwordx4 v[92:95], v18, s[44:47], s52 offen offset:0 nt
    s_bitset1_b32 s52, 15
    s_waitcnt vmcnt(5)
    buffer_load_dwordx4 v[100:103], v18, s[44:47], s52 offen offset:0 nt
    s_bitset0_b32 s52, 15
    s_waitcnt vmcnt(5)
    buffer_load_dwordx4 v[96:99], v18, s[44:47], s52 offen offset:1024 nt
    s_bitset1_b32 s52, 15
    s_waitcnt vmcnt(5)
    buffer_load_dwordx4 v[104:107], v18, s[44:47], s52 offen offset:1024 nt
    s_add_u32 s41, s41, 1
    s_cmp_lt_u32 s41, 29
    s_cbranch_scc1 L_rk0
    s_sub_u32 s35, s41, 28
    s_mov_b64 exec, 1
    v_mov_b32 v15, s35
    ds_write_b32 v14, v15 offset:38176
    s_mov_b64 exec, -1
L_rk0:
    v_mfma_f32_16x16x32_bf16 v[44:47], v[60:63], v[32:35], 0
    v_mfma_f32_16x16x32_bf16 v[48:51], v[64:67], v[32:35], 0
    v_mfma_f32_16x16x32_bf16 v[52:55], v[68:71], v[32:35], 0
    v_mfma_f32_16x16x32_bf16 v[56:59], v[72:75], v[32:35], 0
    s_nop 4
    v_mov_b32_dpp v4, v44 quad_perm:[0,0,0,0] row_mask:0xf bank_mask:0xf
    v_mov_b32_dpp v5, v48 quad_perm:[0,0,0,0] row_mask:0xf bank_mask:0xf
    v_mov_b32_dpp v6, v52 quad_perm:[0,0,0,0] row_mask:0xf bank_mask:0xf
    v_mov_b32_dpp v7, v56 quad_perm:[0,0,0,0] row_mask:0xf bank_mask:0xf
    v_add_f32_dpp v4, v45, v4 quad_perm:[1,1,1,1] row_mask:0xf bank_mask:0xf
    v_add_f32_dpp v5, v49, v5 quad_perm:[1,1,1,1] row_mask:0xf bank_mask:0xf
    v_add_f32_dpp v6, v53, v6 quad_perm:[1,1,1,1] row_mask:0xf bank_mask:0xf
    v_add_f32_dpp v7, v57, v7 quad_perm:[1,1,1,1] row_mask:0xf bank_mask:0xf
    v_add_f32_dpp v4, v46, v4 quad_perm:[2,2,2,2] row_mask:0xf bank_mask:0xf
    v_add_f32_dpp v5, v50, v5 quad_perm:[2,2,2,2] row_mask:0xf bank_mask:0xf
    v_add_f32_dpp v6, v54, v6 quad_perm:[2,2,2,2] row_mask:0xf bank_mask:0xf
    v_add_f32_dpp v7, v58, v7 quad_perm:[2,2,2,2] row_mask:0xf bank_mask:0xf
    v_add_f32_dpp v4, v47, v4 quad_perm:[3,3,3,3] row_mask:0xf bank_mask:0xf
    v_add_f32_dpp v5, v51, v5 quad_perm:[3,3,3,3] row_mask:0xf bank_mask:0xf
    v_add_f32_dpp v6, v55, v6 quad_perm:[3,3,3,3] row_mask:0xf bank_mask:0xf
    v_add_f32_dpp v7, v59, v7 quad_perm:[3,3,3,3] row_mask:0xf bank_mask:0xf
    v_cvt_pk_bf16_f32 v5, v4, v5
    v_cvt_pk_bf16_f32 v7, v6, v7
    v_lshlrev_b32 v4, 16, v5
    v_lshlrev_b32 v6, 16, v7
    v_and_b32 v5, s67, v5
    v_and_b32 v7, s67, v7
    v_mul_f32 v4, s43, v4
    v_mul_f32 v5, s43, v5
    v_mul_f32 v6, s43, v6
    v_mul_f32 v7, s43, v7
    v_cvt_pk_bf16_f32 v5, v4, v5
    v_cvt_pk_bf16_f32 v7, v6, v7
    v_lshlrev_b32 v4, 16, v5
    v_lshlrev_b32 v6, 16, v7
    v_and_b32 v5, s67, v5
    v_and_b32 v7, s67, v7
    v_max3_f32 v1, v4, v5, v6
    v_max3_f32 v1, v1, v7, v20
    v_mov_b32 v2, v1
    s_nop 1
    v_permlane16_swap_b32 v1, v2
    s_nop 0
    v_max_f32 v1, v1, v2
    v_mov_b32 v2, v1
    s_nop 1
    v_permlane32_swap_b32 v1, v2
    s_nop 0
    v_max_f32 v1, v1, v2
    v_sub_f32 v2, v20, v1
    v_mul_f32 v3, s53, v1
    v_mul_f32 v2, s53, v2
    v_mov_b32 v20, v1
    v_exp_f32_e64 v2, v2
    v_fma_f32 v4, v4, s53, -v3
    v_fma_f32 v5, v5, s53, -v3
    v_fma_f32 v6, v6, s53, -v3
    v_fma_f32 v7, v7, s53, -v3
    v_exp_f32 v4, v4
    v_exp_f32 v5, v5
    v_exp_f32 v6, v6
    v_exp_f32 v7, v7
    v_mov_b32_dpp v8, v2 row_newbcast:0 row_mask:0x1 bank_mask:0xf
    v_mov_b32_dpp v8, v2 row_newbcast:4 row_mask:0x2 bank_mask:0xf
    v_mov_b32_dpp v8, v2 row_newbcast:8 row_mask:0x4 bank_mask:0xf
    v_mov_b32_dpp v8, v2 row_newbcast:12 row_mask:0x8 bank_mask:0xf
    v_fma_f32 v21, v21, v2, v4
    v_add_f32 v9, v5, v6
    v_add_f32 v21, v21, v7
    v_add_f32_e64 v21, v21, v9
    v_cvt_pk_bf16_f32 v4, v4, v4
    v_cvt_pk_bf16_f32 v5, v5, v5
    v_cvt_pk_bf16_f32 v6, v6, v6
    v_cvt_pk_bf16_f32 v7, v7, v7
    v_mul_f32 v36, v36, v8
    v_mul_f32 v37, v37, v8
    v_mul_f32 v38, v38, v8
    v_mul_f32 v39, v39, v8
    v_mul_f32 v40, v40, v8
    v_mul_f32 v41, v41, v8
    v_mul_f32 v42, v42, v8
    v_mul_f32 v43, v43, v8
    v_and_b32 v24, v4, v22
    v_and_b32 v25, v4, v23
    v_and_b32 v26, v5, v22
    v_and_b32 v27, v5, v23
    v_and_b32 v28, v6, v22
    v_and_b32 v29, v6, v23
    v_and_b32 v30, v7, v22
    v_and_b32 v31, v7, v23
    s_cmp_eq_u32 s54, 0
    s_cbranch_scc1 L_dv0
    s_waitcnt vmcnt(4)
    buffer_load_dwordx4 v[116:119], v19, s[48:51], s52 offen offset:0 nt
    s_bitset0_b32 s52, 15
    s_waitcnt vmcnt(5)
    buffer_load_dwordx4 v[108:111], v19, s[48:51], s52 offen offset:0 nt
    s_bitset1_b32 s52, 15
    s_waitcnt vmcnt(5)
    buffer_load_dwordx4 v[120:123], v19, s[48:51], s52 offen offset:1024 nt
    s_bitset0_b32 s52, 15
    s_waitcnt vmcnt(5)
    buffer_load_dwordx4 v[112:115], v19, s[48:51], s52 offen offset:1024 nt
    v_mfma_f32_16x16x16_bf16 v[36:39], v[24:25], v[76:77], v[36:39]
    v_mfma_f32_16x16x16_bf16 v[40:43], v[24:25], v[78:79], v[40:43]
    v_mfma_f32_16x16x16_bf16 v[36:39], v[26:27], v[80:81], v[36:39]
    v_mfma_f32_16x16x16_bf16 v[40:43], v[26:27], v[82:83], v[40:43]
    v_mfma_f32_16x16x16_bf16 v[36:39], v[28:29], v[84:85], v[36:39]
    v_mfma_f32_16x16x16_bf16 v[40:43], v[28:29], v[86:87], v[40:43]
    v_mfma_f32_16x16x16_bf16 v[36:39], v[30:31], v[88:89], v[36:39]
    v_mfma_f32_16x16x16_bf16 v[40:43], v[30:31], v[90:91], v[40:43]
    v_readlane_b32 s52, v10, s41
    s_cmp_ge_u32 s41, 29
    s_cbranch_scc1 L_tk1
    s_nop 1
L_gk1:
    s_waitcnt vmcnt(4)
    buffer_load_dwordx4 v[60:63], v18, s[44:47], s52 offen offset:0 nt
    s_bitset1_b32 s52, 15
    s_waitcnt vmcnt(5)
    buffer_load_dwordx4 v[68:71], v18, s[44:47], s52 offen offset:0 nt
    s_bitset0_b32 s52, 15
    s_waitcnt vmcnt(5)
    buffer_load_dwordx4 v[64:67], v18, s[44:47], s52 offen offset:1024 nt
    s_bitset1_b32 s52, 15
    s_waitcnt vmcnt(5)
    buffer_load_dwordx4 v[72:75], v18, s[44:47], s52 offen offset:1024 nt
    s_add_u32 s41, s41, 1
    s_cmp_lt_u32 s41, 29
    s_cbranch_scc1 L_rk1
    s_sub_u32 s35, s41, 28
    s_mov_b64 exec, 1
    v_mov_b32 v15, s35
    ds_write_b32 v14, v15 offset:38176
    s_mov_b64 exec, -1
L_rk1:
    v_mfma_f32_16x16x32_bf16 v[44:47], v[92:95], v[32:35], 0
    v_mfma_f32_16x16x32_bf16 v[48:51], v[96:99], v[32:35], 0
    v_mfma_f32_16x16x32_bf16 v[52:55], v[100:103], v[32:35], 0
    v_mfma_f32_16x16x32_bf16 v[56:59], v[104:107], v[32:35], 0
    s_nop 0
    s_nop 3
    v_mov_b32_dpp v4, v44 quad_perm:[0,0,0,0] row_mask:0xf bank_mask:0xf
    v_mov_b32_dpp v5, v48 quad_perm:[0,0,0,0] row_mask:0xf bank_mask:0xf
    v_mov_b32_dpp v6, v52 quad_perm:[0,0,0,0] row_mask:0xf bank_mask:0xf
    v_mov_b32_dpp v7, v56 quad_perm:[0,0,0,0] row_mask:0xf bank_mask:0xf
    v_add_f32_dpp v4, v45, v4 quad_perm:[1,1,1,1] row_mask:0xf bank_mask:0xf
    v_add_f32_dpp v5, v49, v5 quad_perm:[1,1,1,1] row_mask:0xf bank_mask:0xf
    v_add_f32_dpp v6, v53, v6 quad_perm:[1,1,1,1] row_mask:0xf bank_mask:0xf
    v_add_f32_dpp v7, v57, v7 quad_perm:[1,1,1,1] row_mask:0xf bank_mask:0xf
    v_add_f32_dpp v4, v46, v4 quad_perm:[2,2,2,2] row_mask:0xf bank_mask:0xf
    v_add_f32_dpp v5, v50, v5 quad_perm:[2,2,2,2] row_mask:0xf bank_mask:0xf
    v_add_f32_dpp v6, v54, v6 quad_perm:[2,2,2,2] row_mask:0xf bank_mask:0xf
    v_add_f32_dpp v7, v58, v7 quad_perm:[2,2,2,2] row_mask:0xf bank_mask:0xf
    v_add_f32_dpp v4, v47, v4 quad_perm:[3,3,3,3] row_mask:0xf bank_mask:0xf
    v_add_f32_dpp v5, v51, v5 quad_perm:[3,3,3,3] row_mask:0xf bank_mask:0xf
    v_add_f32_dpp v6, v55, v6 quad_perm:[3,3,3,3] row_mask:0xf bank_mask:0xf
    v_add_f32_dpp v7, v59, v7 quad_perm:[3,3,3,3] row_mask:0xf bank_mask:0xf
    v_cvt_pk_bf16_f32 v5, v4, v5
    v_cvt_pk_bf16_f32 v7, v6, v7
    v_lshlrev_b32 v4, 16, v5
    v_lshlrev_b32 v6, 16, v7
    v_and_b32 v5, s67, v5
    v_and_b32 v7, s67, v7
    v_mul_f32 v4, s43, v4
    v_mul_f32 v5, s43, v5
    v_mul_f32 v6, s43, v6
    v_mul_f32 v7, s43, v7
    v_cvt_pk_bf16_f32 v5, v4, v5
    v_cvt_pk_bf16_f32 v7, v6, v7
    v_lshlrev_b32 v4, 16, v5
    v_lshlrev_b32 v6, 16, v7
    v_and_b32 v5, s67, v5
    v_and_b32 v7, s67, v7
    v_max3_f32 v1, v4, v5, v6
    v_max3_f32 v1, v1, v7, v20
    v_mov_b32 v2, v1
    s_nop 1
    v_permlane16_swap_b32 v1, v2
    s_nop 0
    v_max_f32 v1, v1, v2
    v_mov_b32 v2, v1
    s_nop 1
    v_permlane32_swap_b32 v1, v2
    s_nop 0
    v_max_f32 v1, v1, v2
    v_sub_f32 v2, v20, v1
    v_mul_f32 v3, s53, v1
    v_mul_f32 v2, s53, v2
    v_mov_b32 v20, v1
    v_exp_f32_e64 v2, v2
    v_fma_f32 v4, v4, s53, -v3
    v_fma_f32 v5, v5, s53, -v3
    v_fma_f32 v6, v6, s53, -v3
    v_fma_f32 v7, v7, s53, -v3
    v_exp_f32 v4, v4
    v_exp_f32 v5, v5
    v_exp_f32 v6, v6
    v_exp_f32 v7, v7
    v_mov_b32_dpp v8, v2 row_newbcast:0 row_mask:0x1 bank_mask:0xf
    v_mov_b32_dpp v8, v2 row_newbcast:4 row_mask:0x2 bank_mask:0xf
    v_mov_b32_dpp v8, v2 row_newbcast:8 row_mask:0x4 bank_mask:0xf
    v_mov_b32_dpp v8, v2 row_newbcast:12 row_mask:0x8 bank_mask:0xf
    v_fma_f32 v21, v21, v2, v4
    v_add_f32 v9, v5, v6
    v_add_f32 v21, v21, v7
    v_add_f32_e64 v21, v21, v9
    v_cvt_pk_bf16_f32 v4, v4, v4
    v_cvt_pk_bf16_f32 v5, v5, v5
    v_cvt_pk_bf16_f32 v6, v6, v6
    v_cvt_pk_bf16_f32 v7, v7, v7
    v_mul_f32 v36, v36, v8
    v_mul_f32 v37, v37, v8
    v_mul_f32 v38, v38, v8
    v_mul_f32 v39, v39, v8
    v_mul_f32 v40, v40, v8
    v_mul_f32 v41, v41, v8
    v_mul_f32 v42, v42, v8
    v_mul_f32 v43, v43, v8
    v_and_b32 v24, v4, v22
    v_and_b32 v25, v4, v23
    v_and_b32 v26, v5, v22
    v_and_b32 v27, v5, v23
    v_and_b32 v28, v6, v22
    v_and_b32 v29, v6, v23
    v_and_b32 v30, v7, v22
    v_and_b32 v31, v7, v23
    s_cmp_eq_u32 s54, 0
    s_cbranch_scc1 L_dv1
    s_waitcnt vmcnt(4)
    buffer_load_dwordx4 v[84:87], v19, s[48:51], s52 offen offset:0 nt
    s_bitset0_b32 s52, 15
    s_waitcnt vmcnt(5)
    buffer_load_dwordx4 v[76:79], v19, s[48:51], s52 offen offset:0 nt
    s_bitset1_b32 s52, 15
    s_waitcnt vmcnt(5)
    buffer_load_dwordx4 v[88:91], v19, s[48:51], s52 offen offset:1024 nt
    s_bitset0_b32 s52, 15
    s_waitcnt vmcnt(5)
    buffer_load_dwordx4 v[80:83], v19, s[48:51], s52 offen offset:1024 nt
    v_mfma_f32_16x16x16_bf16 v[36:39], v[24:25], v[108:109], v[36:39]
    v_mfma_f32_16x16x16_bf16 v[40:43], v[24:25], v[110:111], v[40:43]
    v_mfma_f32_16x16x16_bf16 v[36:39], v[26:27], v[112:113], v[36:39]
    v_mfma_f32_16x16x16_bf16 v[40:43], v[26:27], v[114:115], v[40:43]
    v_mfma_f32_16x16x16_bf16 v[36:39], v[28:29], v[116:117], v[36:39]
    v_mfma_f32_16x16x16_bf16 v[40:43], v[28:29], v[118:119], v[40:43]
    v_mfma_f32_16x16x16_bf16 v[36:39], v[30:31], v[120:121], v[36:39]
    v_mfma_f32_16x16x16_bf16 v[40:43], v[30:31], v[122:123], v[40:43]
    s_branch L_loop
L_tk0:
    s_lshl_b32 s35, s41, 2
    s_add_u32 s35, s35, 38604
    v_mov_b32 v15, s35
    s_mov_b32 s40, 8388608
L_tp0:
    ds_read_b32 v16, v15
    s_sub_u32 s40, s40, 1
    s_cbranch_scc1 L_tf0
    s_waitcnt lgkmcnt(0)
    v_readfirstlane_b32 s35, v16
    s_nop 1
    s_cmp_eq_u32 s35, -1
    s_cbranch_scc1 L_tp0
    s_xor_b32 s52, s35, s55
    s_cmp_lt_u32 s35, 0xffffffe0
    s_cbranch_scc1 L_gk0
L_tf0:
    v_and_b32 v1, 3, v0
    v_bfe_u32 v1, s35, v1, 1
    s_and_b32 s36, s2, 3
    s_lshr_b32 s35, s35, s36
    s_and_b32 s35, s35, 1
    s_lshl_b32 s36, s35, 9
    s_lshl_b32 s35, s35, 13
    v_lshlrev_b32 v1, 13, v1
    v_xor_b32 v193, v1, v193
    v_xor_b32 v192, s35, v192
    v_xor_b32 v195, s35, v195
    v_xor_b32 v198, s35, v198
    v_xor_b32 v199, s35, v199
    v_xor_b32 v196, s36, v196
    v_xor_b32 v202, s36, v202
    v_xor_b32 v200, s36, v200
    s_mov_b32 s54, 0
    s_waitcnt vmcnt(4)
    s_branch L_rk0
L_dv0:
    s_cbranch_execz L_g16
    global_load_dwordx4 v[124:127], v202, s[20:21] offset:0
    global_load_dwordx4 v[128:131], v202, s[20:21] offset:1024
    global_load_dwordx4 v[132:135], v202, s[20:21] offset:2048
    global_load_dwordx4 v[136:139], v202, s[20:21] offset:3072
L_g16:
    s_waitcnt vmcnt(4)
    v_mfma_f32_16x16x16_bf16 v[36:39], v[24:25], v[76:77], v[36:39]
    v_mov_b32 v2, v21
    v_mul_f32 v10, s53, v20
    v_mfma_f32_16x16x16_bf16 v[40:43], v[24:25], v[78:79], v[40:43]
    v_permlane16_swap_b32 v21, v2
    v_mfma_f32_16x16x16_bf16 v[36:39], v[26:27], v[80:81], v[36:39]
    v_add_f32 v11, v21, v2
    v_mov_b32 v2, v11
    v_mfma_f32_16x16x16_bf16 v[40:43], v[26:27], v[82:83], v[40:43]
    s_nop 0
    v_permlane32_swap_b32 v11, v2
    v_mfma_f32_16x16x16_bf16 v[36:39], v[28:29], v[84:85], v[36:39]
    v_add_f32 v11, v11, v2
    ds_write_b64 v189, v[10:11] offset:38464
    v_mfma_f32_16x16x16_bf16 v[40:43], v[28:29], v[86:87], v[40:43]
    v_mfma_f32_16x16x16_bf16 v[36:39], v[30:31], v[88:89], v[36:39]
    v_mfma_f32_16x16x16_bf16 v[40:43], v[30:31], v[90:91], v[40:43]
    s_nop 0
    s_cbranch_execnz L_done
    s_branch L_rk1
L_tk1:
    s_lshl_b32 s35, s41, 2
    s_add_u32 s35, s35, 38604
    v_mov_b32 v15, s35
    s_mov_b32 s40, 8388608
L_tp1:
    ds_read_b32 v16, v15
    s_sub_u32 s40, s40, 1
    s_cbranch_scc1 L_tf1
    s_waitcnt lgkmcnt(0)
    v_readfirstlane_b32 s35, v16
    s_nop 1
    s_cmp_eq_u32 s35, -1
    s_cbranch_scc1 L_tp1
    s_xor_b32 s52, s35, s55
    s_cmp_lt_u32 s35, 0xffffffe0
    s_cbranch_scc1 L_gk1
L_tf1:
    v_and_b32 v1, 3, v0
    v_bfe_u32 v1, s35, v1, 1
    s_and_b32 s36, s2, 3
    s_lshr_b32 s35, s35, s36
    s_and_b32 s35, s35, 1
    s_lshl_b32 s36, s35, 9
    s_lshl_b32 s35, s35, 13
    v_lshlrev_b32 v1, 13, v1
    v_xor_b32 v193, v1, v193
    v_xor_b32 v192, s35, v192
    v_xor_b32 v195, s35, v195
    v_xor_b32 v198, s35, v198
    v_xor_b32 v199, s35, v199
    v_xor_b32 v196, s36, v196
    v_xor_b32 v202, s36, v202
    v_xor_b32 v200, s36, v200
    s_mov_b32 s54, 0
    s_waitcnt vmcnt(4)
    s_branch L_rk1
L_dv1:
    s_cbranch_execz L_g17
    global_load_dwordx4 v[124:127], v202, s[20:21] offset:0
    global_load_dwordx4 v[128:131], v202, s[20:21] offset:1024
    global_load_dwordx4 v[132:135], v202, s[20:21] offset:2048
    global_load_dwordx4 v[136:139], v202, s[20:21] offset:3072
L_g17:
    s_waitcnt vmcnt(4)
    v_mfma_f32_16x16x16_bf16 v[36:39], v[24:25], v[108:109], v[36:39]
    v_mov_b32 v2, v21
    v_mul_f32 v10, s53, v20
    v_mfma_f32_16x16x16_bf16 v[40:43], v[24:25], v[110:111], v[40:43]
    v_permlane16_swap_b32 v21, v2
    v_mfma_f32_16x16x16_bf16 v[36:39], v[26:27], v[112:113], v[36:39]
    v_add_f32 v11, v21, v2
    v_mov_b32 v2, v11
    v_mfma_f32_16x16x16_bf16 v[40:43], v[26:27], v[114:115], v[40:43]
    s_nop 0
    v_permlane32_swap_b32 v11, v2
    v_mfma_f32_16x16x16_bf16 v[36:39], v[28:29], v[116:117], v[36:39]
    v_add_f32 v11, v11, v2
    ds_write_b64 v189, v[10:11] offset:38464
    v_mfma_f32_16x16x16_bf16 v[40:43], v[28:29], v[118:119], v[40:43]
    v_mfma_f32_16x16x16_bf16 v[36:39], v[30:31], v[120:121], v[36:39]
    v_mfma_f32_16x16x16_bf16 v[40:43], v[30:31], v[122:123], v[40:43]
    s_nop 0
    s_cbranch_execnz L_done
.p2align 6
L_done:
    s_nop 4
    ds_write_b128 v188, v[36:39] offset:39424
    ds_write_b128 v188, v[40:43] offset:39440
    s_cbranch_execz L_g18
    s_waitcnt lgkmcnt(0)
    s_barrier
L_g18:
    ds_read_b128 v[8:11], v191 offset:38464
    ds_read_b128 v[12:15], v191 offset:38480
    ds_read_b128 v[44:47], v190 offset:39424
    ds_read_b128 v[48:51], v190 offset:41472
    ds_read_b128 v[52:55], v190 offset:43520
    ds_read_b128 v[56:59], v190 offset:45568
    s_waitcnt lgkmcnt(4)
    v_max3_f32 v2, v8, v10, v12
    v_max_f32 v2, v2, v14
    v_sub_f32 v8, v8, v2
    v_sub_f32 v10, v10, v2
    v_sub_f32 v12, v12, v2
    v_sub_f32 v14, v14, v2
    v_exp_f32 v8, v8
    v_exp_f32 v10, v10
    v_exp_f32 v12, v12
    v_exp_f32 v14, v14
    v_mul_f32 v16, v8, v9
    v_fmac_f32 v16, v10, v11
    v_fmac_f32 v16, v12, v13
    v_fmac_f32 v16, v14, v15
    s_waitcnt lgkmcnt(0)
    v_rcp_f32 v4, v16
    v_log_f32_e64 v16, v16
    v_pk_mul_f32 v[36:37], v[44:45], v[8:9] op_sel_hi:[1,0]
    v_pk_mul_f32 v[38:39], v[46:47], v[8:9] op_sel_hi:[1,0]
    v_pk_fma_f32 v[36:37], v[48:49], v[10:11], v[36:37] op_sel_hi:[1,0,1]
    v_pk_fma_f32 v[38:39], v[50:51], v[10:11], v[38:39] op_sel_hi:[1,0,1]
    v_pk_fma_f32 v[36:37], v[52:53], v[12:13], v[36:37] op_sel_hi:[1,0,1]
    v_pk_fma_f32 v[38:39], v[54:55], v[12:13], v[38:39] op_sel_hi:[1,0,1]
    v_pk_fma_f32 v[36:37], v[56:57], v[14:15], v[36:37] op_sel_hi:[1,0,1]
    v_pk_fma_f32 v[38:39], v[58:59], v[14:15], v[38:39] op_sel_hi:[1,0,1]
    v_add_f32 v2, v2, v16
    v_lshrrev_b32 v2, v208, v2
    v_pk_mul_f32 v[36:37], v[36:37], v[4:5] op_sel_hi:[1,0]
    v_pk_mul_f32 v[38:39], v[38:39], v[4:5] op_sel_hi:[1,0]
    v_perm_b32 v36, v36, v2, s60
    v_perm_b32 v37, v37, v2, s61
    v_perm_b32 v38, v38, v210, s60
    s_cbranch_execz L_g19
    s_mov_b32 exec_hi, 0
    global_store_dwordx4 v192, v[36:39], s[26:27] sc1
    ds_write_b128 v190, v[36:39] offset:0
    s_not_b64 exec, s[100:101]
    s_waitcnt lgkmcnt(0)
    s_barrier
    ds_read_b128 v[8:11], v207 offset:0
    s_mov_b64 exec, -1
    global_load_dwordx4 v[140:143], v196, s[12:13] offset:-4096
    global_load_dwordx4 v[144:147], v196, s[12:13] offset:-3072
    global_load_dwordx4 v[148:151], v196, s[12:13] offset:-2048
    global_load_dwordx4 v[152:155], v196, s[12:13] offset:-1024
    global_load_dwordx4 v[156:159], v196, s[12:13] offset:0
    global_load_dwordx4 v[160:163], v196, s[12:13] offset:1024
    global_load_dwordx4 v[164:167], v196, s[12:13] offset:2048
    global_load_dwordx4 v[168:171], v196, s[12:13] offset:3072
    s_mov_b64 exec, s[100:101]
    global_load_dwordx4 v[8:11], v193, s[26:27] sc1
    s_mov_b64 exec, -1
L_g19:
    ds_read_u16 v201, v200 offset:34816
    ds_read_b64 v[24:25], v197 offset:38400
    s_waitcnt vmcnt(10)
    s_nop 0
    v_perm_b32 v60, v128, v124, s64
    v_perm_b32 v61, v128, v124, s65
    v_perm_b32 v62, v129, v125, s64
    v_perm_b32 v63, v129, v125, s65
    v_perm_b32 v64, v130, v126, s64
    v_perm_b32 v65, v130, v126, s65
    v_perm_b32 v66, v131, v127, s64
    v_perm_b32 v67, v131, v127, s65
    v_perm_b32 v68, v136, v132, s64
    v_perm_b32 v69, v136, v132, s65
    v_perm_b32 v70, v137, v133, s64
    v_perm_b32 v71, v137, v133, s65
    v_perm_b32 v72, v138, v134, s64
    v_perm_b32 v73, v138, v134, s65
    v_perm_b32 v74, v139, v135, s64
    v_perm_b32 v75, v139, v135, s65
    s_waitcnt lgkmcnt(0)
    s_nop 0
    v_dot2_f32_bf16 v44, v60, v24, 0
    v_dot2_f32_bf16 v45, v61, v24, 0
    v_dot2_f32_bf16 v46, v62, v24, 0
    v_dot2_f32_bf16 v47, v63, v24, 0
    v_dot2_f32_bf16 v48, v64, v24, 0
    v_dot2_f32_bf16 v49, v65, v24, 0
    v_dot2_f32_bf16 v50, v66, v24, 0
    v_dot2_f32_bf16 v51, v67, v24, 0
    v_dot2_f32_bf16 v44, v68, v25, v44
    v_dot2_f32_bf16 v45, v69, v25, v45
    v_dot2_f32_bf16 v46, v70, v25, v46
    v_dot2_f32_bf16 v47, v71, v25, v47
    v_dot2_f32_bf16 v48, v72, v25, v48
    v_dot2_f32_bf16 v49, v73, v25, v49
    v_dot2_f32_bf16 v50, v74, v25, v50
    v_dot2_f32_bf16 v51, v75, v25, v51
    v_permlane32_swap_b32 v44, v48
    v_permlane32_swap_b32 v45, v49
    v_permlane32_swap_b32 v46, v50
    v_permlane32_swap_b32 v47, v51
    v_add_f32 v44, v44, v48
    v_add_f32 v45, v45, v49
    v_add_f32 v46, v46, v50
    v_add_f32 v47, v47, v51
    s_nop 0
    v_permlane16_swap_b32 v44, v46
    v_permlane16_swap_b32 v45, v47
    v_add_f32 v44, v44, v46
    v_add_f32 v45, v45, v47
    s_nop 0
    v_add_f32_dpp v42, v44, v44 row_ror:8 row_mask:0xf bank_mask:0xf
    v_add_f32_dpp v43, v45, v45 row_ror:8 row_mask:0xf bank_mask:0xf
    v_perm_b32 v43, v43, v211, s60
    s_waitcnt vmcnt(7)
    s_nop 0
    v_perm_b32 v76, v144, v140, s64
    v_perm_b32 v77, v144, v140, s65
    v_perm_b32 v78, v145, v141, s64
    v_perm_b32 v79, v145, v141, s65
    v_perm_b32 v80, v146, v142, s64
    v_perm_b32 v81, v146, v142, s65
    v_perm_b32 v82, v147, v143, s64
    v_perm_b32 v83, v147, v143, s65
    s_waitcnt vmcnt(5)
    s_nop 0
    v_perm_b32 v84, v152, v148, s64
    v_perm_b32 v85, v152, v148, s65
    v_perm_b32 v86, v153, v149, s64
    v_perm_b32 v87, v153, v149, s65
    v_perm_b32 v88, v154, v150, s64
    v_perm_b32 v89, v154, v150, s65
    v_perm_b32 v90, v155, v151, s64
    v_perm_b32 v91, v155, v151, s65
    s_waitcnt vmcnt(3)
    s_nop 0
    v_perm_b32 v92, v160, v156, s64
    v_perm_b32 v93, v160, v156, s65
    v_perm_b32 v94, v161, v157, s64
    v_perm_b32 v95, v161, v157, s65
    v_perm_b32 v96, v162, v158, s64
    v_perm_b32 v97, v162, v158, s65
    v_perm_b32 v98, v163, v159, s64
    v_perm_b32 v99, v163, v159, s65
    s_waitcnt vmcnt(1)
    s_nop 0
    v_perm_b32 v100, v168, v164, s64
    v_perm_b32 v101, v168, v164, s65
    v_perm_b32 v102, v169, v165, s64
    v_perm_b32 v103, v169, v165, s65
    v_perm_b32 v104, v170, v166, s64
    v_perm_b32 v105, v170, v166, s65
    v_perm_b32 v106, v171, v167, s64
    v_perm_b32 v107, v171, v167, s65
    s_mov_b32 s40, 1048576
    s_branch L_p1chk
L_p1poll:
    s_mov_b64 exec, s[100:101]
    global_load_dwordx4 v[8:11], v193, s[26:27] sc1
    s_mov_b64 exec, -1
L_p1chk:
    s_waitcnt vmcnt(0)
    v_cmp_ne_u32_sdwa vcc, v10, v211 src0_sel:BYTE_0 src1_sel:BYTE_0
    s_cbranch_vccz L_p1poll_done
    s_sub_u32 s40, s40, 1
    s_cbranch_scc0 L_p1poll
L_p1poll_done:
    v_perm_b32 v12, v9, v8, v209
    v_perm_b32 v13, v9, v8, v209
    v_and_b32 v8, s39, v8
    v_and_b32 v9, s39, v9
    v_permlane16_swap_b32 v12, v13
    v_and_b32 v10, s39, v10
    v_or_b32 v12, v12, v13
    s_nop 1
    v_max_f32_dpp v2, v12, v12 row_ror:8 row_mask:0xf bank_mask:0xf
    s_nop 1
    v_max_f32_dpp v2, v2, v2 row_ror:4 row_mask:0xf bank_mask:0xf
    s_nop 1
    v_max_f32_dpp v2, v2, v2 row_ror:2 row_mask:0xf bank_mask:0xf
    s_nop 1
    v_max_f32_dpp v2, v2, v2 row_ror:1 row_mask:0xf bank_mask:0xf
    v_sub_f32 v12, v12, v2
    v_exp_f32_e64 v12, v12
    s_nop 0
    v_pk_mul_f32 v[8:9], v[8:9], v[12:13] op_sel_hi:[1,0]
    v_pk_mul_f32 v[10:11], v[10:11], v[12:13] op_sel_hi:[1,0]
    v_add_f32_dpp v12, v12, v12 row_ror:8 row_mask:0xf bank_mask:0xf
    v_add_f32_dpp v8, v8, v8 row_ror:8 row_mask:0xf bank_mask:0xf
    v_add_f32_dpp v9, v9, v9 row_ror:8 row_mask:0xf bank_mask:0xf
    v_add_f32_dpp v10, v10, v10 row_ror:8 row_mask:0xf bank_mask:0xf
    v_add_f32_dpp v11, v11, v11 row_ror:8 row_mask:0xf bank_mask:0xf
    v_add_f32_dpp v12, v12, v12 row_ror:4 row_mask:0xf bank_mask:0xf
    v_add_f32_dpp v8, v8, v8 row_ror:4 row_mask:0xf bank_mask:0xf
    v_add_f32_dpp v9, v9, v9 row_ror:4 row_mask:0xf bank_mask:0xf
    v_add_f32_dpp v10, v10, v10 row_ror:4 row_mask:0xf bank_mask:0xf
    v_add_f32_dpp v11, v11, v11 row_ror:4 row_mask:0xf bank_mask:0xf
    v_add_f32_dpp v12, v12, v12 row_ror:2 row_mask:0xf bank_mask:0xf
    v_add_f32_dpp v8, v8, v8 row_ror:2 row_mask:0xf bank_mask:0xf
    v_add_f32_dpp v9, v9, v9 row_ror:2 row_mask:0xf bank_mask:0xf
    v_add_f32_dpp v10, v10, v10 row_ror:2 row_mask:0xf bank_mask:0xf
    v_add_f32_dpp v11, v11, v11 row_ror:2 row_mask:0xf bank_mask:0xf
    v_add_f32_dpp v12, v12, v12 row_ror:1 row_mask:0xf bank_mask:0xf
    v_add_f32_dpp v8, v8, v8 row_ror:1 row_mask:0xf bank_mask:0xf
    v_rcp_f32_e64 v12, v12
    v_add_f32_dpp v9, v9, v9 row_ror:1 row_mask:0xf bank_mask:0xf
    v_add_f32_dpp v10, v10, v10 row_ror:1 row_mask:0xf bank_mask:0xf
    v_add_f32_dpp v11, v11, v11 row_ror:1 row_mask:0xf bank_mask:0xf
    v_pk_mul_f32 v[8:9], v[8:9], v[12:13] op_sel_hi:[1,0]
    v_pk_mul_f32 v[10:11], v[10:11], v[12:13] op_sel_hi:[1,0]
    v_cvt_pk_bf16_f32 v8, v8, v9
    v_cvt_pk_bf16_f32 v9, v10, v11
    ds_write_b64 v194, v[8:9] offset:38592
    s_cbranch_execz L_g20
    s_waitcnt lgkmcnt(0)
    s_barrier
L_g20:
    ds_read_b128 v[24:27], v203 offset:38592
    s_waitcnt lgkmcnt(0)
    v_dot2_f32_bf16 v44, v76, v24, 0
    v_dot2_f32_bf16 v45, v77, v24, 0
    v_dot2_f32_bf16 v46, v78, v24, 0
    v_dot2_f32_bf16 v47, v79, v24, 0
    v_dot2_f32_bf16 v48, v80, v24, 0
    v_dot2_f32_bf16 v49, v81, v24, 0
    v_dot2_f32_bf16 v50, v82, v24, 0
    v_dot2_f32_bf16 v51, v83, v24, 0
    v_dot2_f32_bf16 v44, v84, v25, v44
    v_dot2_f32_bf16 v45, v85, v25, v45
    v_dot2_f32_bf16 v46, v86, v25, v46
    v_dot2_f32_bf16 v47, v87, v25, v47
    v_dot2_f32_bf16 v48, v88, v25, v48
    v_dot2_f32_bf16 v49, v89, v25, v49
    v_dot2_f32_bf16 v50, v90, v25, v50
    v_dot2_f32_bf16 v51, v91, v25, v51
    v_dot2_f32_bf16 v44, v92, v26, v44
    v_dot2_f32_bf16 v45, v93, v26, v45
    v_dot2_f32_bf16 v46, v94, v26, v46
    v_dot2_f32_bf16 v47, v95, v26, v47
    v_dot2_f32_bf16 v48, v96, v26, v48
    v_dot2_f32_bf16 v49, v97, v26, v49
    v_dot2_f32_bf16 v50, v98, v26, v50
    v_dot2_f32_bf16 v51, v99, v26, v51
    v_dot2_f32_bf16 v44, v100, v27, v44
    v_dot2_f32_bf16 v45, v101, v27, v45
    v_dot2_f32_bf16 v46, v102, v27, v46
    v_dot2_f32_bf16 v47, v103, v27, v47
    v_dot2_f32_bf16 v48, v104, v27, v48
    v_dot2_f32_bf16 v49, v105, v27, v49
    v_dot2_f32_bf16 v50, v106, v27, v50
    v_dot2_f32_bf16 v51, v107, v27, v51
    v_permlane32_swap_b32 v44, v48
    v_permlane32_swap_b32 v45, v49
    v_permlane32_swap_b32 v46, v50
    v_permlane32_swap_b32 v47, v51
    v_add_f32 v44, v44, v48
    v_add_f32 v45, v45, v49
    v_add_f32 v46, v46, v50
    v_add_f32 v47, v47, v51
    s_nop 0
    v_permlane16_swap_b32 v44, v46
    v_permlane16_swap_b32 v45, v47
    v_add_f32 v44, v44, v46
    v_add_f32 v45, v45, v47
    s_nop 0
    v_add_f32_dpp v40, v44, v44 row_ror:8 row_mask:0xf bank_mask:0xf
    v_add_f32_dpp v41, v45, v45 row_ror:8 row_mask:0xf bank_mask:0xf
    s_cbranch_execz L_g21
    s_mov_b64 exec, s[68:69]
    global_store_dwordx4 v195, v[40:43], s[26:27] sc1
    s_mov_b64 exec, -1
L_g21:
    s_and_b32 s35, s29, 3
    s_cbranch_scc1 L_end
    s_mov_b32 s40, 1048576
    v_mov_b32 v6, 0
L_p2poll:
    s_cbranch_execz L_g22
    global_load_dwordx4 v[172:175], v198, s[26:27] sc1
    global_load_dwordx4 v[176:179], v199, s[26:27] sc1
L_g22:
    s_waitcnt vmcnt(0)
    v_xor_b32 v2, v210, v175
    v_bitop3_b32 v2, v2, v179, v210 bitop3:0xf6
    v_cmp_ne_u32_sdwa vcc, v2, v6 src0_sel:BYTE_0 src1_sel:DWORD
    s_cbranch_vccz L_p2poll_done
    s_sub_u32 s40, s40, 1
    s_cbranch_scc0 L_p2poll
L_p2poll_done:
    v_and_b32 v175, s39, v175
    v_and_b32 v179, s39, v179
    v_pk_add_f32 v[8:9], v[172:173], v[176:177]
    v_pk_add_f32 v[10:11], v[174:175], v[178:179]
    s_nop 1
    v_permlane32_swap_b32 v8, v10
    v_permlane32_swap_b32 v9, v11
    s_nop 0
    v_add_f32 v8, v8, v10
    v_add_f32 v9, v9, v11
    s_nop 1
    v_permlane16_swap_b32 v8, v9
    s_nop 0
    v_add_f32 v8, v8, v9
    s_nop 1
    v_add_f32_dpp v8, v8, v8 row_ror:8 row_mask:0xf bank_mask:0xf
    ds_write_b32 v204, v8 offset:39424
    s_cmp_lg_u32 s42, 0
    s_cbranch_execz L_g23
    s_waitcnt lgkmcnt(0)
    s_barrier
L_g23:
    s_cbranch_scc1 L_epoch
    ds_read2_b32 v[24:25], v205 offset0:0 offset1:2
    ds_read2_b32 v[26:27], v205 offset0:32 offset1:34
    ds_read2_b32 v[28:29], v205 offset0:64 offset1:66
    ds_read2_b32 v[30:31], v205 offset0:96 offset1:98
    v_lshlrev_b32 v14, 16, v201
    s_waitcnt lgkmcnt(2)
    v_pk_add_f32 v[24:25], v[24:25], v[26:27]
    s_waitcnt lgkmcnt(0)
    v_pk_add_f32 v[28:29], v[28:29], v[30:31]
    v_pk_add_f32 v[8:9], v[24:25], v[28:29]
    v_cvt_pk_bf16_f32 v8, v8, v9
    v_and_b32 v9, s67, v8
    v_mul_f32 v12, s53, v9
    v_exp_f32 v12, -v12
    v_lshlrev_b32 v8, 16, v8
    v_add_f32 v12, 1.0, v12
    v_rcp_f32 v12, v12
    s_nop 0
    v_mul_f32 v9, v9, v12
    v_cvt_pk_bf16_f32 v9, v9, v9
    v_and_b32 v9, s67, v9
    v_mul_f32 v8, v8, v9
    v_cvt_pk_bf16_f32 v8, v8, v8
    v_and_b32 v8, s67, v8
    v_add_f32 v8, v8, v14
    v_cvt_pk_bf16_f32 v8, v8, v8
    s_cbranch_execz L_end
    s_mov_b64 exec, 0xffff
    global_store_short v200, v8, s[22:23]
    s_endpgm
L_epoch:
    s_lshl2_add_u32 s35, s2, s42
    s_cmp_lg_u32 s35, 9
    s_cbranch_scc1 L_end
    s_mov_b64 exec, 1
    global_store_dword v6, v17, s[26:27]
L_end:
    s_endpgm
.p2align 6
L_wwave:
    s_waitcnt lgkmcnt(0)
    s_barrier
    s_mov_b64 s[44:45], s[6:7]
    s_brev_b32 s46, 16
    s_mov_b32 s47, 0x20000
    s_mov_b64 s[48:49], s[8:9]
    s_brev_b32 s50, 16
    s_mov_b32 s51, 0x20000
    s_mov_b64 s[72:73], s[6:7]
    s_brev_b32 s74, 16
    s_mov_b32 s75, 0x20000
    v_mov_b32 v18, 0
    v_mov_b32 v19, 0
    v_mov_b32 v11, 0
    v_mov_b32 v192, 0
    v_mov_b32 v193, 0
    v_mov_b32 v195, 0
    v_mov_b32 v196, 0
    v_mov_b32 v198, 0
    v_mov_b32 v199, 0
    v_mov_b32 v200, 0
    v_mov_b32 v202, 0
    s_mov_b64 exec, 0
    s_mov_b32 s42, 0
    s_mov_b32 s41, 0
    s_mov_b32 s29, 0
    s_mov_b32 s76, 0
    s_mov_b32 s77, 0
    s_mov_b32 s54, 0
    s_mov_b64 s[96:97], 0
    s_mov_b64 s[98:99], 0
    s_branch L_kpre
L_x2:
    v_lshrrev_b32 v46, 4, v0
    v_bfe_u32 v7, v0, 2, 2
    v_and_b32 v5, 3, v0
    v_lshlrev_b32 v44, 10, v46
    v_lshl_add_u32 v44, v7, 7, v44
    v_lshl_add_u32 v44, v5, 3, v44
    v_and_b32 v45, 1, v0
    v_lshlrev_b32 v4, 10, v45
    v_lshl_add_u32 v4, v46, 4, v4
    v_bfe_u32 v47, v0, 1, 3
    v_bfe_u32 v2, v0, 1, 2
    v_lshlrev_b32 v2, 6, v2
    v_lshl_add_u32 v2, v46, 4, v2
    s_bitcmp1_b32 s2, 3
    s_cbranch_scc1 L_fsetup
    s_lshr_b32 s35, s39, 21
    s_lshl_b32 s43, s35, 9
    s_add_u32 s52, s43, 256
    s_mov_b32 s53, 0
    s_bfe_u32 s36, s39, 0x3000a
    s_lshl_b32 s36, s36, 13
    s_lshl_b32 s37, s35, 11
    s_add_u32 s36, s36, s37
    s_bfe_u32 s37, s39, 0x30007
    s_lshl_b32 s37, s37, 8
    s_add_u32 s36, s36, s37
    s_add_u32 s36, s36, 65536
    v_lshl_add_u32 v3, v45, 12, s36
    s_mov_b32 s54, 0x00ff00ff
    s_branch L_jobset
L_fsetup:
    s_and_b32 s35, s38, 3
    s_lshl_b32 s43, s35, 8
    s_mov_b32 s52, s43
    s_mov_b32 s53, 4
    s_and_b32 s37, s29, 24
    s_min_u32 s37, s37, 22
    s_add_u32 s37, s37, s28
    s_lshl_b32 s37, s37, 8
    s_mul_i32 s36, s35, 7168
    s_add_u32 s36, s36, s37
    s_add_u32 s36, s36, 262144
    v_bfe_u32 v3, v0, 3, 1
    v_lshl_add_u32 v3, v45, 1, v3
    v_mul_u32_u24 v3, 28672, v3
    v_add_u32 v3, s36, v3
    s_mov_b32 s54, -1
L_jobset:
    v_add_u32 v35, v2, v3
    s_mov_b32 s55, s54
    v_mov_b32 v34, 5120
    v_add_u32 v5, s43, v4
    v_cmp_eq_u32 s[44:45], 0, v47
    v_cmp_eq_u32 s[46:47], 1, v47
    v_cmp_eq_u32 s[48:49], 2, v47
    v_cmp_eq_u32 s[50:51], 3, v47
    s_nop 0
    v_cndmask_b32 v36, v34, v5, s[44:45]
    v_cndmask_b32 v37, v34, v5, s[46:47]
    v_cndmask_b32 v38, v34, v5, s[48:49]
    v_cndmask_b32 v39, v34, v5, s[50:51]
    v_add_u32_e64 v5, s52, v4
    v_subrev_u32 v47, s53, v47
    v_cmp_eq_u32 s[44:45], 0, v47
    v_cmp_eq_u32 s[46:47], 1, v47
    v_cmp_eq_u32 s[48:49], 2, v47
    v_cmp_eq_u32 s[50:51], 3, v47
    s_nop 0
    v_cndmask_b32 v40, v34, v5, s[44:45]
    v_cndmask_b32 v41, v34, v5, s[46:47]
    v_cndmask_b32 v42, v34, v5, s[48:49]
    v_cndmask_b32 v43, v34, v5, s[50:51]
    s_waitcnt vmcnt(1)
    s_cmp_eq_u32 s67, 0
    s_cbranch_scc1 L_xok
    s_waitcnt vmcnt(0)
L_xok:
    ds_write_b128 v1, v[8:11] offset:34816
    ds_write_b128 v1, v[12:15] offset:34832
    v_lshlrev_b32 v16, 16, v8
    v_and_b32 v17, 0xffff0000, v8
    v_lshlrev_b32 v18, 16, v9
    v_and_b32 v19, 0xffff0000, v9
    v_lshlrev_b32 v20, 16, v10
    v_and_b32 v21, 0xffff0000, v10
    v_lshlrev_b32 v22, 16, v11
    v_and_b32 v23, 0xffff0000, v11
    v_lshlrev_b32 v24, 16, v12
    v_and_b32 v25, 0xffff0000, v12
    v_lshlrev_b32 v26, 16, v13
    v_and_b32 v27, 0xffff0000, v13
    v_lshlrev_b32 v28, 16, v14
    v_and_b32 v29, 0xffff0000, v14
    v_lshlrev_b32 v30, 16, v15
    v_and_b32 v31, 0xffff0000, v15
    v_add_f32 v6, v16, v17
    v_add_f32 v6, v6, v18
    v_add_f32 v6, v6, v19
    v_add_f32 v6, v6, v20
    v_add_f32 v6, v6, v21
    v_add_f32 v6, v6, v22
    v_add_f32 v6, v6, v23
    v_add_f32 v6, v6, v24
    v_add_f32 v6, v6, v25
    v_add_f32 v6, v6, v26
    v_add_f32 v6, v6, v27
    v_add_f32 v6, v6, v28
    v_add_f32 v6, v6, v29
    v_add_f32 v6, v6, v30
    v_add_f32 v6, v6, v31
    s_nop 1
    v_add_f32_dpp v6, v6, v6 row_ror:8 row_mask:0xf bank_mask:0xf
    s_nop 1
    v_add_f32_dpp v6, v6, v6 row_ror:4 row_mask:0xf bank_mask:0xf
    s_nop 1
    v_add_f32_dpp v6, v6, v6 row_ror:2 row_mask:0xf bank_mask:0xf
    s_nop 1
    v_add_f32_dpp v6, v6, v6 row_ror:1 row_mask:0xf bank_mask:0xf
    s_nop 1
    v_mov_b32 v7, v6
    s_nop 1
    v_permlane16_swap_b32 v6, v7
    s_nop 0
    v_add_f32 v6, v6, v7
    v_mul_f32 v6, 0x3b000000, v6
    v_sub_f32 v32, v16, v6
    v_mul_f32 v33, v32, v32
    v_sub_f32 v32, v17, v6
    v_fmac_f32 v33, v32, v32
    v_sub_f32 v32, v18, v6
    v_fmac_f32 v33, v32, v32
    v_sub_f32 v32, v19, v6
    v_fmac_f32 v33, v32, v32
    v_sub_f32 v32, v20, v6
    v_fmac_f32 v33, v32, v32
    v_sub_f32 v32, v21, v6
    v_fmac_f32 v33, v32, v32
    v_sub_f32 v32, v22, v6
    v_fmac_f32 v33, v32, v32
    v_sub_f32 v32, v23, v6
    v_fmac_f32 v33, v32, v32
    v_sub_f32 v32, v24, v6
    v_fmac_f32 v33, v32, v32
    v_sub_f32 v32, v25, v6
    v_fmac_f32 v33, v32, v32
    v_sub_f32 v32, v26, v6
    v_fmac_f32 v33, v32, v32
    v_sub_f32 v32, v27, v6
    v_fmac_f32 v33, v32, v32
    v_sub_f32 v32, v28, v6
    v_fmac_f32 v33, v32, v32
    v_sub_f32 v32, v29, v6
    v_fmac_f32 v33, v32, v32
    v_sub_f32 v32, v30, v6
    v_fmac_f32 v33, v32, v32
    v_sub_f32 v32, v31, v6
    v_fmac_f32 v33, v32, v32
    s_nop 1
    v_add_f32_dpp v33, v33, v33 row_ror:8 row_mask:0xf bank_mask:0xf
    s_nop 1
    v_add_f32_dpp v33, v33, v33 row_ror:4 row_mask:0xf bank_mask:0xf
    s_nop 1
    v_add_f32_dpp v33, v33, v33 row_ror:2 row_mask:0xf bank_mask:0xf
    s_nop 1
    v_add_f32_dpp v33, v33, v33 row_ror:1 row_mask:0xf bank_mask:0xf
    s_nop 1
    v_mov_b32 v7, v33
    s_nop 1
    v_permlane16_swap_b32 v33, v7
    s_nop 0
    v_add_f32 v33, v33, v7
    v_mul_f32 v33, 0x3b000000, v33
    v_cvt_pk_bf16_f32 v6, v6, v33
    v_and_b32 v33, 0xffff0000, v6
    v_lshlrev_b32 v6, 16, v6
    v_add_f32 v33, 0x3727c5ac, v33
    v_cvt_pk_bf16_f32 v33, v33, v33
    v_lshlrev_b32 v33, 16, v33
    v_sqrt_f32 v33, v33
    s_nop 0
    v_cvt_pk_bf16_f32 v33, v33, v33
    v_lshlrev_b32 v33, 16, v33
    v_rcp_f32 v33, v33
    v_sub_f32 v16, v16, v6
    v_sub_f32 v17, v17, v6
    v_cvt_pk_bf16_f32 v8, v16, v17
    v_lshlrev_b32 v16, 16, v8
    v_and_b32 v17, 0xffff0000, v8
    v_mul_f32 v16, v16, v33
    v_mul_f32 v17, v17, v33
    v_cvt_pk_bf16_f32 v8, v16, v17
    v_sub_f32 v18, v18, v6
    v_sub_f32 v19, v19, v6
    v_cvt_pk_bf16_f32 v9, v18, v19
    v_lshlrev_b32 v18, 16, v9
    v_and_b32 v19, 0xffff0000, v9
    v_mul_f32 v18, v18, v33
    v_mul_f32 v19, v19, v33
    v_cvt_pk_bf16_f32 v9, v18, v19
    v_sub_f32 v20, v20, v6
    v_sub_f32 v21, v21, v6
    v_cvt_pk_bf16_f32 v10, v20, v21
    v_lshlrev_b32 v20, 16, v10
    v_and_b32 v21, 0xffff0000, v10
    v_mul_f32 v20, v20, v33
    v_mul_f32 v21, v21, v33
    v_cvt_pk_bf16_f32 v10, v20, v21
    v_sub_f32 v22, v22, v6
    v_sub_f32 v23, v23, v6
    v_cvt_pk_bf16_f32 v11, v22, v23
    v_lshlrev_b32 v22, 16, v11
    v_and_b32 v23, 0xffff0000, v11
    v_mul_f32 v22, v22, v33
    v_mul_f32 v23, v23, v33
    v_cvt_pk_bf16_f32 v11, v22, v23
    v_sub_f32 v24, v24, v6
    v_sub_f32 v25, v25, v6
    v_cvt_pk_bf16_f32 v12, v24, v25
    v_lshlrev_b32 v24, 16, v12
    v_and_b32 v25, 0xffff0000, v12
    v_mul_f32 v24, v24, v33
    v_mul_f32 v25, v25, v33
    v_cvt_pk_bf16_f32 v12, v24, v25
    v_sub_f32 v26, v26, v6
    v_sub_f32 v27, v27, v6
    v_cvt_pk_bf16_f32 v13, v26, v27
    v_lshlrev_b32 v26, 16, v13
    v_and_b32 v27, 0xffff0000, v13
    v_mul_f32 v26, v26, v33
    v_mul_f32 v27, v27, v33
    v_cvt_pk_bf16_f32 v13, v26, v27
    v_sub_f32 v28, v28, v6
    v_sub_f32 v29, v29, v6
    v_cvt_pk_bf16_f32 v14, v28, v29
    v_lshlrev_b32 v28, 16, v14
    v_and_b32 v29, 0xffff0000, v14
    v_mul_f32 v28, v28, v33
    v_mul_f32 v29, v29, v33
    v_cvt_pk_bf16_f32 v14, v28, v29
    v_sub_f32 v30, v30, v6
    v_sub_f32 v31, v31, v6
    v_cvt_pk_bf16_f32 v15, v30, v31
    v_lshlrev_b32 v30, 16, v15
    v_and_b32 v31, 0xffff0000, v15
    v_mul_f32 v30, v30, v33
    v_mul_f32 v31, v31, v33
    v_cvt_pk_bf16_f32 v15, v30, v31
    ds_write_b128 v1, v[8:11] offset:32768
    ds_write_b128 v1, v[12:15] offset:32784
    s_waitcnt lgkmcnt(0)
    s_add_u32 s33, s33, 0x9e3779b9
    s_mov_b32 s56, s33
    s_lshr_b32 s57, s33, 8
    s_lshr_b32 s58, s33, 16
    s_lshr_b32 s59, s33, 24
    s_mov_b32 s60, 0x7060500
    s_mov_b32 s61, 0x7060501
    s_mov_b32 s62, 0x7060502
    s_mov_b32 s63, 0x7060503
    v_mov_b32 v32, s33
    v_mov_b32 v33, 1
    s_barrier
    s_andn2_b32 s35, 0x8e, s2
    s_cbranch_scc0 L_nojob
    s_nop 0
    ds_read_b128 v[48:51], v36 offset:32768
    ds_read_b64_tr_b16 v[52:53], v44 offset:0
    ds_read_b64_tr_b16 v[54:55], v44 offset:512
    ds_read_b128 v[56:59], v37 offset:32768
    ds_read_b64_tr_b16 v[60:61], v44 offset:32
    ds_read_b64_tr_b16 v[62:63], v44 offset:544
    ds_read_b128 v[64:67], v38 offset:32768
    ds_read_b64_tr_b16 v[68:69], v44 offset:64
    ds_read_b64_tr_b16 v[70:71], v44 offset:576
    ds_read_b128 v[72:75], v39 offset:32768
    ds_read_b64_tr_b16 v[76:77], v44 offset:96
    ds_read_b64_tr_b16 v[78:79], v44 offset:608
    s_waitcnt lgkmcnt(9)
    v_mfma_f32_16x16x32_bf16 v[8:11], v[52:55], v[48:51], 0
    ds_read_b128 v[48:51], v36 offset:32832
    ds_read_b64_tr_b16 v[52:53], v44 offset:4096
    ds_read_b64_tr_b16 v[54:55], v44 offset:4608
    s_waitcnt lgkmcnt(9)
    v_mfma_f32_16x16x32_bf16 v[8:11], v[60:63], v[56:59], v[8:11]
    ds_read_b128 v[56:59], v37 offset:32832
    ds_read_b64_tr_b16 v[60:61], v44 offset:4128
    ds_read_b64_tr_b16 v[62:63], v44 offset:4640
    s_waitcnt lgkmcnt(9)
    v_mfma_f32_16x16x32_bf16 v[8:11], v[68:71], v[64:67], v[8:11]
    ds_read_b128 v[64:67], v38 offset:32832
    ds_read_b64_tr_b16 v[68:69], v44 offset:4160
    ds_read_b64_tr_b16 v[70:71], v44 offset:4672
    s_waitcnt lgkmcnt(9)
    v_mfma_f32_16x16x32_bf16 v[8:11], v[76:79], v[72:75], v[8:11]
    ds_read_b128 v[72:75], v39 offset:32832
    ds_read_b64_tr_b16 v[76:77], v44 offset:4192
    ds_read_b64_tr_b16 v[78:79], v44 offset:4704
    s_waitcnt lgkmcnt(9)
    v_mfma_f32_16x16x32_bf16 v[8:11], v[52:55], v[48:51], v[8:11]
    ds_read_b128 v[48:51], v36 offset:32896
    ds_read_b64_tr_b16 v[52:53], v44 offset:8192
    ds_read_b64_tr_b16 v[54:55], v44 offset:8704
    s_waitcnt lgkmcnt(9)
    v_mfma_f32_16x16x32_bf16 v[8:11], v[60:63], v[56:59], v[8:11]
    ds_read_b128 v[56:59], v37 offset:32896
    ds_read_b64_tr_b16 v[60:61], v44 offset:8224
    ds_read_b64_tr_b16 v[62:63], v44 offset:8736
    s_waitcnt lgkmcnt(9)
    v_mfma_f32_16x16x32_bf16 v[8:11], v[68:71], v[64:67], v[8:11]
    ds_read_b128 v[64:67], v38 offset:32896
    ds_read_b64_tr_b16 v[68:69], v44 offset:8256
    ds_read_b64_tr_b16 v[70:71], v44 offset:8768
    s_waitcnt lgkmcnt(9)
    v_mfma_f32_16x16x32_bf16 v[8:11], v[76:79], v[72:75], v[8:11]
    ds_read_b128 v[72:75], v39 offset:32896
    ds_read_b64_tr_b16 v[76:77], v44 offset:8288
    ds_read_b64_tr_b16 v[78:79], v44 offset:8800
    s_waitcnt lgkmcnt(9)
    v_mfma_f32_16x16x32_bf16 v[8:11], v[52:55], v[48:51], v[8:11]
    ds_read_b128 v[48:51], v36 offset:32960
    ds_read_b64_tr_b16 v[52:53], v44 offset:12288
    ds_read_b64_tr_b16 v[54:55], v44 offset:12800
    s_waitcnt lgkmcnt(9)
    v_mfma_f32_16x16x32_bf16 v[8:11], v[60:63], v[56:59], v[8:11]
    ds_read_b128 v[56:59], v37 offset:32960
    ds_read_b64_tr_b16 v[60:61], v44 offset:12320
    ds_read_b64_tr_b16 v[62:63], v44 offset:12832
    s_waitcnt lgkmcnt(9)
    v_mfma_f32_16x16x32_bf16 v[8:11], v[68:71], v[64:67], v[8:11]
    ds_read_b128 v[64:67], v38 offset:32960
    ds_read_b64_tr_b16 v[68:69], v44 offset:12352
    ds_read_b64_tr_b16 v[70:71], v44 offset:12864
    s_waitcnt lgkmcnt(9)
    v_mfma_f32_16x16x32_bf16 v[8:11], v[76:79], v[72:75], v[8:11]
    ds_read_b128 v[72:75], v39 offset:32960
    ds_read_b64_tr_b16 v[76:77], v44 offset:12384
    ds_read_b64_tr_b16 v[78:79], v44 offset:12896
    s_waitcnt lgkmcnt(9)
    v_mfma_f32_16x16x32_bf16 v[8:11], v[52:55], v[48:51], v[8:11]
    ds_read_b128 v[48:51], v40 offset:32768
    ds_read_b64_tr_b16 v[52:53], v44 offset:16384
    ds_read_b64_tr_b16 v[54:55], v44 offset:16896
    s_waitcnt lgkmcnt(9)
    v_mfma_f32_16x16x32_bf16 v[8:11], v[60:63], v[56:59], v[8:11]
    ds_read_b128 v[56:59], v41 offset:32768
    ds_read_b64_tr_b16 v[60:61], v44 offset:16416
    ds_read_b64_tr_b16 v[62:63], v44 offset:16928
    s_waitcnt lgkmcnt(9)
    v_mfma_f32_16x16x32_bf16 v[8:11], v[68:71], v[64:67], v[8:11]
    ds_read_b128 v[64:67], v42 offset:32768
    ds_read_b64_tr_b16 v[68:69], v44 offset:16448
    ds_read_b64_tr_b16 v[70:71], v44 offset:16960
    s_waitcnt lgkmcnt(9)
    v_mfma_f32_16x16x32_bf16 v[8:11], v[76:79], v[72:75], v[8:11]
    ds_read_b128 v[72:75], v43 offset:32768
    ds_read_b64_tr_b16 v[76:77], v44 offset:16480
    ds_read_b64_tr_b16 v[78:79], v44 offset:16992
    s_waitcnt lgkmcnt(9)
    v_mfma_f32_16x16x32_bf16 v[8:11], v[52:55], v[48:51], v[8:11]
    ds_read_b128 v[48:51], v40 offset:32832
    ds_read_b64_tr_b16 v[52:53], v44 offset:20480
    ds_read_b64_tr_b16 v[54:55], v44 offset:20992
    s_waitcnt lgkmcnt(9)
    v_mfma_f32_16x16x32_bf16 v[8:11], v[60:63], v[56:59], v[8:11]
    ds_read_b128 v[56:59], v41 offset:32832
    ds_read_b64_tr_b16 v[60:61], v44 offset:20512
    ds_read_b64_tr_b16 v[62:63], v44 offset:21024
    s_waitcnt lgkmcnt(9)
    v_mfma_f32_16x16x32_bf16 v[8:11], v[68:71], v[64:67], v[8:11]
    ds_read_b128 v[64:67], v42 offset:32832
    ds_read_b64_tr_b16 v[68:69], v44 offset:20544
    ds_read_b64_tr_b16 v[70:71], v44 offset:21056
    s_waitcnt lgkmcnt(9)
    v_mfma_f32_16x16x32_bf16 v[8:11], v[76:79], v[72:75], v[8:11]
    ds_read_b128 v[72:75], v43 offset:32832
    ds_read_b64_tr_b16 v[76:77], v44 offset:20576
    ds_read_b64_tr_b16 v[78:79], v44 offset:21088
    s_waitcnt lgkmcnt(9)
    v_mfma_f32_16x16x32_bf16 v[8:11], v[52:55], v[48:51], v[8:11]
    ds_read_b128 v[48:51], v40 offset:32896
    ds_read_b64_tr_b16 v[52:53], v44 offset:24576
    ds_read_b64_tr_b16 v[54:55], v44 offset:25088
    s_waitcnt lgkmcnt(9)
    v_mfma_f32_16x16x32_bf16 v[8:11], v[60:63], v[56:59], v[8:11]
    ds_read_b128 v[56:59], v41 offset:32896
    ds_read_b64_tr_b16 v[60:61], v44 offset:24608
    ds_read_b64_tr_b16 v[62:63], v44 offset:25120
    s_waitcnt lgkmcnt(9)
    v_mfma_f32_16x16x32_bf16 v[8:11], v[68:71], v[64:67], v[8:11]
    ds_read_b128 v[64:67], v42 offset:32896
    ds_read_b64_tr_b16 v[68:69], v44 offset:24640
    ds_read_b64_tr_b16 v[70:71], v44 offset:25152
    s_waitcnt lgkmcnt(9)
    v_mfma_f32_16x16x32_bf16 v[8:11], v[76:79], v[72:75], v[8:11]
    ds_read_b128 v[72:75], v43 offset:32896
    ds_read_b64_tr_b16 v[76:77], v44 offset:24672
    ds_read_b64_tr_b16 v[78:79], v44 offset:25184
    s_waitcnt lgkmcnt(9)
    v_mfma_f32_16x16x32_bf16 v[8:11], v[52:55], v[48:51], v[8:11]
    ds_read_b128 v[48:51], v40 offset:32960
    ds_read_b64_tr_b16 v[52:53], v44 offset:28672
    ds_read_b64_tr_b16 v[54:55], v44 offset:29184
    s_waitcnt lgkmcnt(9)
    v_mfma_f32_16x16x32_bf16 v[8:11], v[60:63], v[56:59], v[8:11]
    ds_read_b128 v[56:59], v41 offset:32960
    ds_read_b64_tr_b16 v[60:61], v44 offset:28704
    ds_read_b64_tr_b16 v[62:63], v44 offset:29216
    s_waitcnt lgkmcnt(9)
    v_mfma_f32_16x16x32_bf16 v[8:11], v[68:71], v[64:67], v[8:11]
    ds_read_b128 v[64:67], v42 offset:32960
    ds_read_b64_tr_b16 v[68:69], v44 offset:28736
    ds_read_b64_tr_b16 v[70:71], v44 offset:29248
    s_waitcnt lgkmcnt(9)
    v_mfma_f32_16x16x32_bf16 v[8:11], v[76:79], v[72:75], v[8:11]
    ds_read_b128 v[72:75], v43 offset:32960
    ds_read_b64_tr_b16 v[76:77], v44 offset:28768
    ds_read_b64_tr_b16 v[78:79], v44 offset:29280
    s_waitcnt lgkmcnt(9)
    v_mfma_f32_16x16x32_bf16 v[8:11], v[52:55], v[48:51], v[8:11]
    s_waitcnt lgkmcnt(6)
    v_mfma_f32_16x16x32_bf16 v[8:11], v[60:63], v[56:59], v[8:11]
    s_waitcnt lgkmcnt(3)
    v_mfma_f32_16x16x32_bf16 v[8:11], v[68:71], v[64:67], v[8:11]
    s_waitcnt lgkmcnt(0)
    v_mfma_f32_16x16x32_bf16 v[8:11], v[76:79], v[72:75], v[8:11]
    s_nop 0
    s_nop 6
    v_add_u32 v8, 0x80, v8
    v_add_u32 v9, 0x80, v9
    v_add_u32 v10, 0x80, v10
    v_add_u32 v11, 0x80, v11
    v_perm_b32 v8, v8, v32, s60
    v_perm_b32 v9, v9, v32, s61
    v_perm_b32 v10, v10, v32, s62
    v_perm_b32 v11, v11, v32, s63
    s_mov_b64 exec, s[54:55]
    s_waitcnt vmcnt(0)
    global_store_dwordx4 v35, v[8:11], s[26:27] sc1
    s_mov_b64 exec, -1
L_nojob:
    s_lshl_b32 s55, s38, 23
    s_bfe_i32 s35, s38, 0x10000
    s_and_b32 s35, s35, 0x2000
    s_xor_b32 s55, s55, s35
    v_lshrrev_b32 v3, 4, v0
    v_add_u32 v3, 29, v3
    v_mov_b32 v20, s55
    v_bfe_i32 v7, v3, 0, 1
    v_and_b32 v7, 0x2000, v7
    v_xor_b32 v20, v20, v7
    v_bfe_i32 v7, v3, 1, 1
    v_and_b32 v7, 0x10000, v7
    v_xor_b32 v20, v20, v7
    v_bfe_i32 v7, v3, 2, 1
    v_and_b32 v7, 0x4000, v7
    v_xor_b32 v20, v20, v7
    v_bfe_i32 v7, v3, 3, 1
    v_and_b32 v7, 0x20000, v7
    v_xor_b32 v20, v20, v7
    v_bfe_i32 v7, v3, 4, 1
    v_and_b32 v7, 0x40000, v7
    v_xor_b32 v20, v20, v7
    v_bfe_i32 v7, v0, 0, 1
    v_and_b32 v7, 0x84000, v7
    v_xor_b32 v20, v20, v7
    v_bfe_i32 v7, v0, 1, 1
    v_and_b32 v7, 0x120000, v7
    v_xor_b32 v20, v20, v7
    v_bfe_i32 v7, v0, 2, 1
    v_and_b32 v7, 0x200000, v7
    v_xor_b32 v20, v20, v7
    v_bfe_i32 v7, v0, 3, 1
    v_and_b32 v7, 0x402000, v7
    v_xor_b32 v20, v20, v7
    s_mul_i32 s36, s38, 1280
    s_add_u32 s36, s36, 393216
    s_add_u32 s68, s26, s36
    s_addc_u32 s69, s27, 0
    s_lshr_b32 s35, s28, 2
    s_and_b32 s36, s28, 2
    s_or_b32 s35, s35, s36
    s_and_b32 s36, s28, 1
    s_lshr_b32 s37, s29, 2
    s_lshl3_add_u32 s36, s36, s37
    v_add_u32 v2, s36, v0
    v_and_b32 v2, 15, v2
    s_and_b32 s37, s29, 3
    s_lshl2_add_u32 s36, s35, s37
    s_lshl_b32 s36, s36, 15
    s_add_u32 s36, s36, 524288
    v_lshl_add_u32 v22, v0, 11, s36
    v_lshl_add_u32 v22, v2, 7, v22
    v_lshrrev_b32 v7, 4, v22
    v_xor_b32 v7, v7, v22
    v_bfe_i32 v7, v7, 13, 1
    v_and_b32 v7, 0x22000, v7
    v_xor_b32 v22, v22, v7
    v_mov_b32 v6, -1
    v_mov_b32 v7, -1
    v_lshlrev_b32 v21, 3, v0
    ds_write_b64 v21, v[6:7] offset:38720
    s_lshl_b32 s36, s30, 13
    s_lshl_b32 s37, s31, 12
    s_add_u32 s36, s36, s37
    s_add_u32 s36, s36, 65536
    v_lshl_add_u32 v1, v0, 4, s36
    s_mul_i32 s36, s34, 112
    s_mul_i32 s37, s31, 57344
    s_add_u32 s36, s36, s37
    s_add_u32 s36, s36, 262144
    v_lshrrev_b32 v2, 3, v0
    v_mul_u32_u24 v2, 7168, v2
    v_and_b32 v3, 7, v0
    v_min_u32 v3, 6, v3
    v_lshl_add_u32 v2, v3, 4, v2
    v_add_u32 v2, s36, v2
    v_and_b32 v5, 12, v0
    s_mov_b32 s40, 8388608
L_go:
    ds_read_b32 v6, v5 offset:38160
    s_waitcnt lgkmcnt(0)
    v_cmp_ne_u32 vcc, 0, v6
    s_cbranch_vccnz L_go_done
    s_sleep 1
    s_sub_u32 s40, s40, 1
    s_cbranch_scc0 L_go
L_go_done:
    s_nop 0
    s_mov_b32 s40, 1048576
L_qpoll:
    global_load_dwordx4 v[48:51], v1, s[26:27] offset:0 sc1
    global_load_dwordx4 v[52:55], v1, s[26:27] offset:1024 sc1
    global_load_dwordx4 v[56:59], v1, s[26:27] offset:2048 sc1
    global_load_dwordx4 v[60:63], v1, s[26:27] offset:3072 sc1
    global_load_dwordx4 v[8:11], v2, s[26:27] sc1
    s_waitcnt vmcnt(0)
    v_xor_b32 v6, s56, v48
    v_bitop3_b32 v6, v6, v49, s57 bitop3:0xf6
    v_bitop3_b32 v6, v6, v50, s58 bitop3:0xf6
    v_bitop3_b32 v6, v6, v51, s59 bitop3:0xf6
    v_bitop3_b32 v6, v6, v52, s56 bitop3:0xf6
    v_bitop3_b32 v6, v6, v53, s57 bitop3:0xf6
    v_bitop3_b32 v6, v6, v54, s58 bitop3:0xf6
    v_bitop3_b32 v6, v6, v55, s59 bitop3:0xf6
    v_bitop3_b32 v6, v6, v56, s56 bitop3:0xf6
    v_bitop3_b32 v6, v6, v57, s57 bitop3:0xf6
    v_bitop3_b32 v6, v6, v58, s58 bitop3:0xf6
    v_bitop3_b32 v6, v6, v59, s59 bitop3:0xf6
    v_bitop3_b32 v6, v6, v60, s56 bitop3:0xf6
    v_bitop3_b32 v6, v6, v61, s57 bitop3:0xf6
    v_bitop3_b32 v6, v6, v62, s58 bitop3:0xf6
    v_bitop3_b32 v6, v6, v63, s59 bitop3:0xf6
    v_bitop3_b32 v6, v6, v8, s56 bitop3:0xf6
    v_bitop3_b32 v6, v6, v9, s57 bitop3:0xf6
    v_bitop3_b32 v6, v6, v10, s58 bitop3:0xf6
    v_bitop3_b32 v6, v6, v11, s59 bitop3:0xf6
    v_and_b32 v6, 0xff, v6
    v_cmp_ne_u32 vcc, 0, v6
    s_cbranch_vccz L_qpoll_done
    s_sub_u32 s40, s40, 1
    s_cbranch_scc0 L_qpoll
L_qpoll_done:
    v_and_b32 v48, 0xffffff00, v48
    v_and_b32 v49, 0xffffff00, v49
    v_and_b32 v50, 0xffffff00, v50
    v_and_b32 v51, 0xffffff00, v51
    v_and_b32 v52, 0xffffff00, v52
    v_and_b32 v53, 0xffffff00, v53
    v_and_b32 v54, 0xffffff00, v54
    v_and_b32 v55, 0xffffff00, v55
    v_and_b32 v56, 0xffffff00, v56
    v_and_b32 v57, 0xffffff00, v57
    v_and_b32 v58, 0xffffff00, v58
    v_and_b32 v59, 0xffffff00, v59
    v_and_b32 v60, 0xffffff00, v60
    v_and_b32 v61, 0xffffff00, v61
    v_and_b32 v62, 0xffffff00, v62
    v_and_b32 v63, 0xffffff00, v63
    v_add_f32 v48, v48, v56
    v_add_f32 v49, v49, v57
    v_add_f32 v50, v50, v58
    v_add_f32 v51, v51, v59
    v_add_f32 v52, v52, v60
    v_add_f32 v53, v53, v61
    v_add_f32 v54, v54, v62
    v_add_f32 v55, v55, v63
    v_cvt_pk_bf16_f32 v48, v48, v49
    v_cvt_pk_bf16_f32 v49, v50, v51
    v_cvt_pk_bf16_f32 v50, v52, v53
    v_cvt_pk_bf16_f32 v51, v54, v55
    v_mov_b32 v6, 0
    v_mov_b32 v7, 0
    ds_write_b64 v21, v[48:49] offset:36864
    ds_write_b64 v21, v[50:51] offset:37376
    s_waitcnt lgkmcnt(0)
    ds_write_b64 v6, v[32:33] offset:38144
    s_setprio 0
    v_and_b32 v8, 0xffffff00, v8
    v_and_b32 v9, 0xffffff00, v9
    v_and_b32 v10, 0xffffff00, v10
    v_and_b32 v11, 0xffffff00, v11
    v_add_f32_dpp v8, v8, v8 row_ror:8 row_mask:0xf bank_mask:0xf
    v_add_f32_dpp v9, v9, v9 row_ror:8 row_mask:0xf bank_mask:0xf
    v_add_f32_dpp v10, v10, v10 row_ror:8 row_mask:0xf bank_mask:0xf
    v_add_f32_dpp v11, v11, v11 row_ror:8 row_mask:0xf bank_mask:0xf
    v_mov_b32 v12, v8
    v_mov_b32 v13, v9
    v_mov_b32 v14, v10
    v_mov_b32 v15, v11
    v_permlane16_swap_b32 v8, v12
    v_permlane16_swap_b32 v9, v13
    v_permlane16_swap_b32 v10, v14
    v_permlane16_swap_b32 v11, v15
    v_add_f32 v8, v8, v12
    v_add_f32 v9, v9, v13
    v_add_f32 v10, v10, v14
    v_add_f32 v11, v11, v15
    v_cvt_pk_bf16_f32 v8, v8, v9
    v_cvt_pk_bf16_f32 v9, v10, v11
    v_mov_b32 v10, v8
    v_mov_b32 v11, v9
    s_nop 1
    v_permlane32_swap_b32 v8, v10
    v_permlane32_swap_b32 v9, v11
    v_lshlrev_b32 v12, 16, v8
    v_and_b32 v13, 0xffff0000, v8
    v_lshlrev_b32 v14, 16, v10
    v_and_b32 v15, 0xffff0000, v10
    v_max_f32 v12, 0, v12
    v_max_f32 v13, 0, v13
    v_mul_f32 v12, v12, v14
    v_mul_f32 v13, v13, v15
    v_cvt_pk_bf16_f32 v16, v12, v13
    v_lshlrev_b32 v12, 16, v9
    v_and_b32 v13, 0xffff0000, v9
    v_lshlrev_b32 v14, 16, v11
    v_and_b32 v15, 0xffff0000, v11
    v_max_f32 v12, 0, v12
    v_max_f32 v13, 0, v13
    v_mul_f32 v12, v12, v14
    v_mul_f32 v13, v13, v15
    v_cvt_pk_bf16_f32 v17, v12, v13
    v_lshlrev_b32 v3, 3, v3
    ds_write_b64 v3, v[16:17] offset:38400
    ds_write_b64 v6, v[6:7] offset:38456
    s_cmp_ge_u32 s2, 4
    s_cbranch_scc1 L_norace
    s_lshl_b32 s36, s2, 8
    s_add_u32 s36, s36, 458752
    v_lshl_add_u32 v1, v0, 10, s36
    s_mov_b64 exec, 0xffff
    global_store_dword v1, v33, s[26:27] sc1
    s_mov_b32 s43, 0
    s_waitcnt vmcnt(0) lgkmcnt(0)
L_race:
    s_mov_b64 s[46:47], 0
    s_add_u32 s37, s36, 0x2000
    s_load_dword s46, s[26:27], s36
    s_load_dword s47, s[26:27], s37
    s_waitcnt lgkmcnt(1)
    s_sub_u32 s45, s47, s46
    s_add_u32 s43, s43, s45
    s_add_u32 s36, s36, 1024
    s_waitcnt lgkmcnt(0)
    s_mov_b64 s[46:47], 0
    s_add_u32 s37, s36, 0x2000
    s_load_dword s47, s[26:27], s37
    s_load_dword s46, s[26:27], s36
    s_waitcnt lgkmcnt(1)
    s_sub_u32 s45, s47, s46
    s_add_u32 s43, s43, s45
    s_add_u32 s36, s36, 1024
    s_waitcnt lgkmcnt(0)
    s_cmp_lt_u32 s36, 466944
    s_cbranch_scc1 L_race
    v_mov_b32 v12, s33
    v_mov_b32 v13, s43
    s_lshl_b64 exec, 1, s2
    global_store_dwordx2 v21, v[12:13], s[26:27] offset:2048 sc1
    s_mov_b64 exec, -1
L_norace:
    s_mov_b32 s41, 0
    v_mov_b32 v5, 38720
    s_mov_b32 s40, 8388608
    s_setprio 1
L_disp:
    ds_read_b128 v[8:11], v6 offset:38176
    s_sub_u32 s40, s40, 1
    s_cbranch_scc1 L_disp_done
    s_waitcnt lgkmcnt(0)
    v_min3_u32 v8, v8, v9, v10
    v_min_u32 v8, v8, v11
    v_cmp_lt_u32 vcc, s41, v8
    s_cbranch_vccnz L_serve
    s_sleep 1
    s_branch L_disp
L_serve:
    s_mov_b64 exec, 1
    global_atomic_add v12, v6, v33, s[68:69] sc0
    s_cmp_lg_u32 s41, 0
    s_cbranch_scc1 L_haveflag
    s_mov_b64 exec, 15
    global_load_dwordx2 v[14:15], v21, s[26:27] offset:2048 sc1
L_haveflag:
    s_mov_b64 exec, -1
    s_add_u32 s41, s41, 1
    s_waitcnt vmcnt(0)
    v_readfirstlane_b32 s67, v12
    s_nop 3
    v_readlane_b32 s36, v20, s67
    s_cmp_lt_u32 s67, 48
    s_cbranch_scc0 L_empty
    v_mov_b32 v7, s36
    ds_write_b32 v5, v7
    v_add_u32 v5, 4, v5
    s_branch L_disp
L_flag:
    global_load_dwordx2 v[14:15], v21, s[26:27] offset:2048 sc1
    s_waitcnt vmcnt(0)
L_empty:
    s_mov_b64 exec, 15
    v_cmp_ne_u32 vcc, s33, v14
    s_cbranch_vccz L_flag_done
    s_sub_u32 s40, s40, 1
    s_cbranch_scc0 L_flag
L_flag_done:
    v_cmp_lt_i32 vcc, 0, v15
    s_mov_b64 exec, -1
    s_and_b32 s37, s2, 3
    s_or_b32 s36, vcc_lo, 0xffffffe0
    v_mov_b32 v7, s36
    ds_write_b32 v5, v7
    s_lshr_b32 s36, s36, s37
    s_and_b32 s36, s36, 1
    s_lshl_b32 s36, s36, 13
    v_xor_b32 v22, s36, v22
L_disp_done:
    s_mov_b64 exec, 0xffff
    global_load_dword v23, v22, s[26:27] sc1
    s_waitcnt lgkmcnt(0)
    s_barrier
    s_endpgm
.section .rodata,"a"
.p2align 6
.amdhsa_kernel recurrent_scan__gqa_block_cached__glu_gated_reglu__decode_kernel
  .amdhsa_next_free_vgpr 216
  .amdhsa_next_free_sgpr 102
  .amdhsa_accum_offset 216
  .amdhsa_group_segment_fixed_size 0
  .amdhsa_kernarg_size 96
  .amdhsa_user_sgpr_count 2
  .amdhsa_user_sgpr_kernarg_segment_ptr 1
  .amdhsa_system_sgpr_workgroup_id_x 1
  .amdhsa_float_denorm_mode_32 3
.end_amdhsa_kernel
```
